```python
import torch

def _softmax(x, axis=-1):
    return torch.softmax(x, dim=axis)
def _gelu(x):
    return torch.nn.functional.gelu(x, approximate="tanh")
def _silu(x):
    return torch.nn.functional.silu(x)
def _sigmoid(x):
    return torch.sigmoid(x)
def _layernorm(x, axis=-1, eps=1e-5):
    m = x.mean(dim=axis, keepdim=True)
    v = x.var(dim=axis, keepdim=True, unbiased=False)
    return (x - m) / torch.sqrt(v + eps)
def _scatter_add(tgt, idx, src, axis=0):
    return tgt.clone().index_add_(axis, idx, src)
def _segment_sum(src, seg, n):
    out = torch.zeros((n,) + src.shape[1:], dtype=src.dtype)
    return out.index_add_(0, seg, src)
def _pad(x, pw):
    flat = tuple(v for pair in reversed(pw) for v in pair)
    return torch.nn.functional.pad(x, flat)

kernel_name = 'gated_mix__softmax_full_mha__linear_kernel_hedgehog__prompt'

def setup_inputs():

    _w = (lambda a: (lambda t: t.to(torch.bfloat16) if t.is_floating_point() else t)(torch.as_tensor(a)))
    def _A_setup():
        B, S, D = 1, 2048, 512
        return {
            "x": _w((lambda *s: torch.randn(*s, dtype=torch.bfloat16) * 0.05)(B, S, D)),
            "wqkv": _w((lambda *s: torch.randn(*s, dtype=torch.bfloat16) * 0.8)(D, 3 * D)),
            "wo": _w((lambda *s: torch.randn(*s, dtype=torch.bfloat16) * 0.05)(D, D)),
        }
    _A_in = _A_setup()

    def _B_setup():
        B, S, D, H = 1, 2048, 512, 32
        Dh = D // H
        return {
            "x": _w((lambda *s: torch.randn(*s, dtype=torch.bfloat16) * 0.05)(B, S, D)),
            "wqkv": _w((lambda *s: torch.randn(*s, dtype=torch.bfloat16) * 1.6)(D, 3 * D)),
            "w_phi": _w((lambda *s: torch.randn(*s, dtype=torch.bfloat16) * 1.6)(H, Dh, Dh) * (Dh ** -0.5)),
            "wo": _w((lambda *s: torch.randn(*s, dtype=torch.bfloat16) * 0.05)(D, D)),
        }
    _B_in = _B_setup()

    return {
        "A_x": _A_in["x"],
        "A_wqkv": _A_in["wqkv"],
        "A_wo": _A_in["wo"],
        "B_x": _B_in["x"],
        "B_wqkv": _B_in["wqkv"],
        "B_w_phi": _B_in["w_phi"],
        "B_wo": _B_in["wo"],
        "gate_w": _w((lambda *s: torch.randn(*s, dtype=torch.bfloat16) * 0.05)(512) * 16.0),
    }

def reference(A_x, A_wqkv, A_wo, B_x, B_wqkv, B_w_phi, B_wo, gate_w):
    def _A_ref(x, wqkv, wo):
        B, S, D = x.shape
        H = 32; Dh = D // H
        qkv = (lambda x, *d: x.permute(*d))((x @ wqkv).reshape(B, S, 3, H, Dh), 2, 0, 3, 1, 4)
        q, k, v = qkv[0], qkv[1], qkv[2]
        scale = Dh ** -0.5
        scores = torch.einsum("bhqd,bhkd->bhqk", q, k) * scale
        p = _softmax(scores, axis=-1)
        o = torch.einsum("bhqk,bhkd->bhqd", p, v)
        return (lambda x, *d: x.permute(*d))(o, 0, 2, 1, 3).reshape(B, S, D) @ wo

    def _B_ref(x, wqkv, w_phi, wo):
        B, S, D = x.shape
        H = 32; Dh = D // H
        qkv = (lambda x, *d: x.permute(*d))((x @ wqkv).reshape(B, S, 3, H, Dh), 2, 0, 3, 1, 4)
        q, k, v = qkv[0], qkv[1], qkv[2]
        pq = torch.einsum("bhsd,hdf->bhsf", q, w_phi)
        pk = torch.einsum("bhsd,hdf->bhsf", k, w_phi)
        phi_q = torch.concatenate([_softmax(pq, axis=-1), _softmax(-pq, axis=-1)], axis=-1)
        phi_k = torch.concatenate([_softmax(pk, axis=-1), _softmax(-pk, axis=-1)], axis=-1)
        kv = torch.einsum("bhsf,bhsd->bhfd", phi_k, v)
        z  = torch.einsum("bhsf->bhf", phi_k)
        num = torch.einsum("bhqf,bhfd->bhqd", phi_q, kv)
        den = torch.einsum("bhqf,bhf->bhq", phi_q, z)[..., None] + 1e-6
        o = num / den
        return (lambda x, *d: x.permute(*d))(o, 0, 2, 1, 3).reshape(B, S, D) @ wo

    x = A_x
    g = _sigmoid((x * gate_w).sum(-1, keepdims=True))
    a = _A_ref(x, A_wqkv, A_wo)
    b = _B_ref(x, B_wqkv, B_w_phi, B_wo)
    return g * a + (1 - g) * b
```

```asm
; @launch kernel=fz_kernel grid=(256,1,1) block=(512,1,1) lds=163840
.amdgcn_target "amdgcn-amd-amdhsa--gfx950"
.text
.globl fz_kernel
.p2align 8
.type fz_kernel,@function
fz_kernel:
    s_cmp_ge_u32 s2, 256
    s_cbranch_scc1 fz_kernel_exit
    s_load_dwordx16 s[4:19], s[0:1], 0
    s_load_dwordx4 s[20:23], s[0:1], 64
    s_load_dwordx2 s[24:25], s[0:1], 80
    v_lshrrev_b32 v1, 6, v0
    v_and_b32 v250, 63, v0
    v_lshlrev_b32 v251, 4, v250
    v_readfirstlane_b32 s3, v1
    s_cmp_lg_u32 s3, 0
    s_cbranch_scc1 fz_kernel_npf
    s_getpc_b64 s[68:69]
fz_kernel_pf:
    s_lshr_b32 s64, s2, 3
    s_mul_i32 s64, s64, 2048
    v_lshl_add_u32 v2, v0, 7, s64
    s_mov_b64 exec, 0xffff
    v_min_u32 v2, fz_kernel_end-fz_kernel_pf-4, v2
    global_load_dword v247, v2, s[68:69]
    s_mov_b64 exec, -1
fz_kernel_npf:
    s_and_b32 s54, s2, 7
    s_bfe_u32 s52, s2, 0x40003
    s_lshr_b32 s55, s2, 7
    s_xor_b32 s55, s55, 1
    s_lshl_b32 s53, s54, 1
    s_add_u32 s53, s53, s55
    s_add_u32 s56, s52, s54
    s_cmp_lt_u32 s3, 4
    s_cbranch_scc1 fz_kernel_comp
    s_sub_u32 s70, s3, 4
    v_lshrrev_b32 v108, 3, v250
    s_lshl_b32 s64, s70, 5
    v_add_u32 v109, s64, v108
    v_lshlrev_b32 v109, 10, v109
    v_lshrrev_b32 v110, 4, v250
    v_and_b32 v111, 7, v250
    v_xor_b32 v112, v111, v110
    v_lshl_add_u32 v20, v112, 4, v109
    v_xor_b32 v112, 4, v112
    v_lshl_add_u32 v21, v112, 4, v109
    v_add_u32 v21, 7168, v21
    v_add_u32 v22, 14336, v20
    v_add_u32 v23, 14336, v21
    s_lshl_b32 s64, s70, 4
    v_add_u32 v109, s64, v108
    v_mul_u32_u24 v109, 3072, v109
    v_and_b32 v112, 1, v110
    v_lshlrev_b32 v112, 2, v112
    v_xor_b32 v112, v111, v112
    v_lshl_add_u32 v24, v112, 4, v109
    v_add_u32 v25, 23552, v24
    s_lshl_b32 s64, s54, 7
    s_lshl_b32 s76, s55, 10
    s_add_u32 s76, s76, s64
    s_add_u32 s77, s64, 2048
    s_xor_b32 s78, s76, 1024
    s_lshl_b32 s71, s52, 17
    s_lshl_b32 s72, s70, 12
    s_lshl_b32 s73, s70, 11
    s_and_b32 s79, s56, 7
    s_xor_b32 s79, s79, s55
    s_mov_b32 s30, 0x200000
    s_mov_b32 s31, 0x00020000
    s_mov_b32 s34, 0x180000
    s_mov_b32 s35, 0x00020000
    s_mov_b32 s38, 0x180000
    s_mov_b32 s39, 0x00020000
    s_mov_b32 s42, 0x180000
    s_mov_b32 s43, 0x00020000
    s_lshl_b32 s74, s79, 7
    s_add_u32 m0, s72, 32000
    s_add_u32 s74, s74, s71
    s_cmp_eq_u32 s55, 0
    s_waitcnt lgkmcnt(0)
    s_mov_b64 s[28:29], s[4:5]
    s_mov_b64 s[32:33], s[6:7]
    s_cselect_b64 s[36:37], s[12:13], s[6:7]
    s_mov_b64 s[40:41], s[12:13]
    buffer_load_dwordx4 v20, s[28:31], s74 offen offset:0 lds
    buffer_load_dwordx4 v21, s[28:31], s74 offen offset:1024 lds
    buffer_load_dwordx4 v22, s[28:31], s74 offen offset:2048 lds
    buffer_load_dwordx4 v23, s[28:31], s74 offen offset:3072 lds
    s_mul_i32 s75, s79, 196608
    s_add_u32 m0, s73, 113920
    s_add_u32 s74, s75, s76
    buffer_load_dwordx4 v24, s[32:35], s74 offen offset:0 lds
    buffer_load_dwordx4 v25, s[32:35], s74 offen offset:1024 lds
    s_add_u32 m0, s73, 122112
    s_add_u32 s74, s75, s77
    buffer_load_dwordx4 v24, s[36:39], s74 offen offset:0 lds
    buffer_load_dwordx4 v25, s[36:39], s74 offen offset:1024 lds
    s_add_u32 m0, s73, 130304
    s_add_u32 s74, s75, s78
    buffer_load_dwordx4 v24, s[40:43], s74 offen offset:0 lds
    buffer_load_dwordx4 v25, s[40:43], s74 offen offset:1024 lds
    s_and_b32 s65, s3, 2
    s_lshl2_add_u32 s58, s52, s65
    s_cmp_lt_u32 s3, 4
    s_addc_u32 s58, s58, 0
    s_lshl_b32 s57, s53, 4
    s_add_u32 s57, s57, s52
    s_lshl_b32 s57, s57, 10
    s_and_b32 s64, s2, 7
    s_lshl_b32 s64, s64, 2
    s_bfe_u32 s65, s2, 0x20003
    s_add_u32 s61, s64, s65
    s_lshr_b32 s62, s2, 5
    s_lshl_b32 s64, s62, 3
    s_add_u32 s64, s64, s3
    s_lshl_b32 s59, s64, 6
    s_add_u32 s59, s59, s61
    s_lshl_b32 s59, s59, 10
    s_add_u32 s59, s59, 0xd00000
    s_lshl_b32 s64, s62, 5
    s_add_u32 s64, s64, s61
    s_mul_i32 s64, s64, 1024
    s_mul_i32 s60, s3, 128
    s_add_u32 s60, s60, s64
    s_add_u32 s60, s60, 0x1140000
    s_mov_b32 s68, 0x3fb8aa3b
    s_mov_b32 s69, 0x3fb8aa3b
    s_lshl_b32 s64, s55, 1
    s_lshl_b32 s63, 1, s64
    s_and_b32 s65, s3, 4
    s_lshl2_add_u32 s63, s65, s63
    s_lshl3_add_u32 s64, s55, s3
    s_bitcmp1_b32 0x10, s64
    s_cselect_b32 s65, 2, 0
    s_or_b32 s63, s63, s65
    s_bitcmp1_b32 0x2020, s64
    s_cselect_b32 s65, 8, 0
    s_or_b32 s63, s63, s65
    s_mov_b32 s44, s24
    s_mov_b32 s45, s25
    s_mov_b32 s46, 0x1500000
    s_mov_b32 s47, 0x00020000
    s_mov_b32 s64, 0x1180000
    buffer_load_dword v249, off, s[44:47], s64
    v_and_b32 v101, 3, v250
    v_lshlrev_b32 v101, 6, v101
    v_mov_b32 v240, 0
    ds_write_b32 v101, v240 offset:30720
    s_add_u32 s64, s55, 6
    v_lshlrev_b32 v102, s64, v250
    s_lshl2_add_u32 s91, s54, s70
    s_lshl4_add_u32 s91, s91, s52
    s_lshl_b32 s91, s91, 12
    s_lshl_b32 s91, s91, s55
    s_mul_i32 s64, s55, 0x200000
    s_add_u32 s91, s91, s64
    v_cmp_gt_u32 vcc, 8, v250
    v_and_b32 v108, 6, v250
    v_and_b32 v109, 1, v250
    v_lshl_add_u32 v108, v108, 1, v109
    s_add_u32 s64, s72, 16384
    v_lshl_add_u32 v108, v108, 8, s64
    s_lshl_b32 s64, s62, 11
    s_and_b32 s65, s70, 2
    s_lshl_b32 s65, s65, 7
    s_add_u32 s64, s64, s65
    v_lshl_add_u32 v109, v109, 10, s64
    v_cndmask_b32 v243, v109, v108, vcc
    s_lshl_b32 s89, s54, 15
    s_and_b32 s64, s61, 2
    s_lshl_b32 s64, s64, 6
    s_add_u32 s89, s89, s64
    s_add_u32 s89, s89, 0x1100000
    s_mov_b32 s85, 0x8000
    s_mov_b32 s84, 0
    s_lshl_b32 s86, s61, 17
    s_lshl_b32 s64, s70, 15
    s_add_u32 s86, s86, s64
    s_add_u32 s86, s86, 0x200000
    s_lshl_b32 s87, s61, 6
    s_lshl_b32 s64, s62, 3
    s_add_u32 s87, s87, s64
    s_add_u32 s87, s87, s70
    s_lshl_b32 s87, s87, 10
    s_mul_i32 s88, s70, 8256
    v_and_b32 v16, 0x1f0, v251
    v_lshrrev_b32 v17, 5, v250
    v_lshl_add_u32 v17, v17, 10, v16
    s_lshl_b32 s90, s53, 13
    s_add_u32 s90, s90, s73
    s_add_u32 s90, s90, s71
    v_lshrrev_b32 v110, 5, v250
    v_and_b32 v108, 31, v250
    v_lshlrev_b32 v109, 2, v110
    v_sub_u32 v108, v108, v109
    v_and_b32 v109, 1, v108
    v_lshlrev_b32 v109, 4, v109
    v_mov_b32 v128, 0x3f80
    v_lshlrev_b32 v109, v109, v128
    v_and_b32 v108, -2, v108
    v_cmp_eq_u32 vcc, 0, v108
    s_nop 1
    v_cndmask_b32 v128, 0, v109, vcc
    v_cmp_eq_u32 vcc, 2, v108
    s_nop 1
    v_cndmask_b32 v129, 0, v109, vcc
    v_cmp_eq_u32 vcc, 8, v108
    s_nop 1
    v_cndmask_b32 v130, 0, v109, vcc
    v_cmp_eq_u32 vcc, 10, v108
    s_nop 1
    v_cndmask_b32 v131, 0, v109, vcc
    v_cmp_eq_u32 vcc, 16, v108
    s_nop 1
    v_cndmask_b32 v132, 0, v109, vcc
    v_cmp_eq_u32 vcc, 18, v108
    s_nop 1
    v_cndmask_b32 v133, 0, v109, vcc
    v_cmp_eq_u32 vcc, 24, v108
    s_nop 1
    v_cndmask_b32 v134, 0, v109, vcc
    v_cmp_eq_u32 vcc, 26, v108
    s_nop 1
    v_cndmask_b32 v135, 0, v109, vcc
    s_and_b32 s64, s3, 1
    s_lshl_b32 s64, s64, 10
    v_lshrrev_b32 v110, 5, v250
    v_bfe_u32 v108, v250, 2, 2
    v_lshl_add_u32 v108, v110, 2, v108
    v_and_b32 v110, 3, v250
    v_lshl_add_u32 v110, v110, 3, s64
    v_lshl_add_u32 v110, v108, 5, v110
    v_add_u32 v109, s73, v251
    s_add_u32 s79, s56, 1
    s_and_b32 s79, s79, 7
    s_xor_b32 s79, s79, s55
    s_lshl_b32 s74, s79, 7
    s_add_u32 m0, s72, 48384
    s_add_u32 s74, s74, s71
    buffer_load_dwordx4 v20, s[28:31], s74 offen offset:0 lds
    buffer_load_dwordx4 v21, s[28:31], s74 offen offset:1024 lds
    buffer_load_dwordx4 v22, s[28:31], s74 offen offset:2048 lds
    buffer_load_dwordx4 v23, s[28:31], s74 offen offset:3072 lds
    s_mul_i32 s75, s79, 196608
    s_add_u32 m0, s73, 138496
    s_add_u32 s74, s75, s76
    buffer_load_dwordx4 v24, s[32:35], s74 offen offset:0 lds
    buffer_load_dwordx4 v25, s[32:35], s74 offen offset:1024 lds
    s_add_u32 m0, s73, 146688
    s_add_u32 s74, s75, s77
    s_waitcnt vmcnt(11)
    s_barrier
    buffer_load_dwordx4 v24, s[36:39], s74 offen offset:0 lds
    buffer_load_dwordx4 v25, s[36:39], s74 offen offset:1024 lds
    s_add_u32 m0, s73, 154880
    s_add_u32 s74, s75, s78
    buffer_load_dwordx4 v24, s[40:43], s74 offen offset:0 lds
    buffer_load_dwordx4 v25, s[40:43], s74 offen offset:1024 lds
    s_add_u32 s79, s56, 2
    s_and_b32 s79, s79, 7
    s_xor_b32 s79, s79, s55
    s_lshl_b32 s74, s79, 7
    s_add_u32 m0, s72, 64768
    s_add_u32 s74, s74, s71
    s_waitcnt vmcnt(11)
    s_barrier
    buffer_load_dwordx4 v20, s[28:31], s74 offen offset:0 lds
    buffer_load_dwordx4 v21, s[28:31], s74 offen offset:1024 lds
    buffer_load_dwordx4 v22, s[28:31], s74 offen offset:2048 lds
    buffer_load_dwordx4 v23, s[28:31], s74 offen offset:3072 lds
    s_mul_i32 s75, s79, 196608
    s_add_u32 m0, s73, 81152
    s_add_u32 s74, s75, s76
    buffer_load_dwordx4 v24, s[32:35], s74 offen offset:0 lds
    buffer_load_dwordx4 v25, s[32:35], s74 offen offset:1024 lds
    s_add_u32 m0, s73, 89344
    s_add_u32 s74, s75, s77
    buffer_load_dwordx4 v24, s[36:39], s74 offen offset:0 lds
    buffer_load_dwordx4 v25, s[36:39], s74 offen offset:1024 lds
    s_add_u32 m0, s73, 97536
    s_add_u32 s74, s75, s78
    buffer_load_dwordx4 v24, s[40:43], s74 offen offset:0 lds
    buffer_load_dwordx4 v25, s[40:43], s74 offen offset:1024 lds
    s_add_u32 s79, s56, 3
    s_and_b32 s79, s79, 7
    s_xor_b32 s79, s79, s55
    s_lshl_b32 s74, s79, 7
    s_add_u32 m0, s72, 32000
    s_add_u32 s74, s74, s71
    s_waitcnt vmcnt(10)
    s_barrier
    buffer_load_dwordx4 v20, s[28:31], s74 offen offset:0 lds
    buffer_load_dwordx4 v21, s[28:31], s74 offen offset:1024 lds
    buffer_load_dwordx4 v22, s[28:31], s74 offen offset:2048 lds
    buffer_load_dwordx4 v23, s[28:31], s74 offen offset:3072 lds
    s_mul_i32 s75, s79, 196608
    s_add_u32 m0, s73, 105728
    s_add_u32 s74, s75, s76
    buffer_load_dwordx4 v24, s[32:35], s74 offen offset:0 lds
    buffer_load_dwordx4 v25, s[32:35], s74 offen offset:1024 lds
    s_add_u32 m0, s73, 113920
    s_add_u32 s74, s75, s77
    buffer_load_dwordx4 v24, s[36:39], s74 offen offset:0 lds
    buffer_load_dwordx4 v25, s[36:39], s74 offen offset:1024 lds
    s_add_u32 m0, s73, 122112
    s_add_u32 s74, s75, s78
    buffer_load_dwordx4 v24, s[40:43], s74 offen offset:0 lds
    buffer_load_dwordx4 v25, s[40:43], s74 offen offset:1024 lds
    s_and_b32 s64, s58, 3
    s_lshl_b32 s64, s64, 9
    s_and_b32 s65, s3, 1
    s_lshl_b32 s94, s65, 6
    s_add_u32 s94, s94, s64
    s_mul_i32 s95, s65, 16512
    s_add_u32 s95, s95, s64
    s_add_u32 s95, s95, 15360
    s_lshr_b32 s64, s3, 1
    s_lshl_b32 s64, s64, 5
    s_mul_i32 s65, s65, 4128
    s_add_u32 s96, s64, s65
    s_mul_i32 s97, s3, 4128
    s_add_u32 s97, s97, 15360
    s_mov_b32 s26, 0xffff
    s_mov_b32 s27, 0xffff
    v_lshrrev_b32 v104, 5, v250
    v_and_b32 v105, 31, v250
    v_min_u32 v241, 16, v105
    v_mad_u32_u24 v241, v104, 17, v241
    v_lshlrev_b32 v241, 4, v241
    v_add_u32 v65, 31744, v251
    v_add_u32 v66, 97792, v251
    v_mov_b32 v64, 0xdddddddd
    v_and_b32 v106, 0xf0, v251
    v_lshl_add_u32 v106, v104, 8, v106
    v_add_u32 v67, 32768, v106
    v_mov_b32 v0, 0x3f803f80
    v_lshl_add_u32 v105, v104, 4, s94
    v_add_u32 v107, s95, v106
    v_cndmask_b32_e64 v1, v105, v107, s[26:27]
    v_add_u32 v107, 8224, v107
    v_cndmask_b32_e64 v2, v107, v105, s[26:27]
    v_lshl_add_u32 v105, v104, 4, s96
    v_add_u32 v107, s97, v106
    v_cndmask_b32_e64 v242, v105, v107, s[26:27]
    s_mov_b32 vcc_lo, 0x110000
    s_mov_b32 vcc_hi, 0x110000
    v_mov_b32 v3, 0
    v_mov_b32 v8, 0
    v_mov_b32 v9, 0
    v_mov_b32 v10, 0
    v_mov_b32 v11, 0
    v_mov_b32 v4, 0
    v_mov_b32 v5, 0
    v_mov_b32 v6, 0
    v_mov_b32 v7, 0
    v_mov_b32 v12, 0
    v_mov_b32 v13, 0
    v_mov_b32 v14, 0
    v_mov_b32 v15, 0
    v_bfe_u32 v247, v250, 3, 2
    v_and_b32 v104, 7, v250
    v_lshl_add_u32 v247, v247, 11, v104
    v_lshlrev_b32 v247, 3, v247
    v_cndmask_b32 v56, 0, v0, vcc
    v_cndmask_b32 v57, 0, v0, vcc
    v_cndmask_b32 v58, 0, v0, vcc
    v_cndmask_b32 v59, 0, v0, vcc
    v_cndmask_b32 v60, 0, v0, vcc
    v_cndmask_b32 v61, 0, v0, vcc
    v_cndmask_b32 v62, 0, v0, vcc
    v_cndmask_b32 v63, 0, v0, vcc
    v_add_u32 v252, 1024, v109
    s_add_u32 s79, s56, 4
    s_and_b32 s79, s79, 7
    s_xor_b32 s79, s79, s55
    s_lshl_b32 s74, s79, 7
    s_add_u32 m0, s72, 48384
    s_add_u32 s74, s74, s71
    s_waitcnt vmcnt(10)
    s_barrier
    buffer_load_dwordx4 v20, s[28:31], s74 offen offset:0 lds
    buffer_load_dwordx4 v21, s[28:31], s74 offen offset:1024 lds
    buffer_load_dwordx4 v22, s[28:31], s74 offen offset:2048 lds
    buffer_load_dwordx4 v23, s[28:31], s74 offen offset:3072 lds
    s_mul_i32 s75, s79, 196608
    s_add_u32 m0, s73, 130304
    s_add_u32 s74, s75, s76
    buffer_load_dwordx4 v24, s[32:35], s74 offen offset:0 lds
    buffer_load_dwordx4 v25, s[32:35], s74 offen offset:1024 lds
    s_add_u32 m0, s73, 138496
    s_add_u32 s74, s75, s77
    buffer_load_dwordx4 v24, s[36:39], s74 offen offset:0 lds
    buffer_load_dwordx4 v25, s[36:39], s74 offen offset:1024 lds
    s_add_u32 m0, s73, 146688
    s_add_u32 s74, s75, s78
    buffer_load_dwordx4 v24, s[40:43], s74 offen offset:0 lds
    buffer_load_dwordx4 v25, s[40:43], s74 offen offset:1024 lds
    s_add_u32 s79, s56, 5
    s_and_b32 s79, s79, 7
    s_xor_b32 s79, s79, s55
    s_lshl_b32 s74, s79, 7
    s_add_u32 m0, s72, 64768
    s_add_u32 s74, s74, s71
    s_waitcnt vmcnt(10)
    s_barrier
    buffer_load_dwordx4 v20, s[28:31], s74 offen offset:0 lds
    buffer_load_dwordx4 v21, s[28:31], s74 offen offset:1024 lds
    buffer_load_dwordx4 v22, s[28:31], s74 offen offset:2048 lds
    buffer_load_dwordx4 v23, s[28:31], s74 offen offset:3072 lds
    s_mul_i32 s75, s79, 196608
    s_add_u32 m0, s73, 154880
    s_add_u32 s74, s75, s76
    buffer_load_dwordx4 v24, s[32:35], s74 offen offset:0 lds
    buffer_load_dwordx4 v25, s[32:35], s74 offen offset:1024 lds
    s_add_u32 m0, s73, 81152
    s_add_u32 s74, s75, s77
    buffer_load_dwordx4 v24, s[36:39], s74 offen offset:0 lds
    buffer_load_dwordx4 v25, s[36:39], s74 offen offset:1024 lds
    s_add_u32 s79, s56, 6
    s_and_b32 s79, s79, 7
    s_xor_b32 s79, s79, s55
    s_lshl_b32 s74, s79, 7
    s_add_u32 m0, s72, 32000
    s_add_u32 s74, s74, s71
    s_waitcnt vmcnt(8)
    s_barrier
    buffer_load_dwordx4 v20, s[28:31], s74 offen offset:0 lds
    buffer_load_dwordx4 v21, s[28:31], s74 offen offset:1024 lds
    buffer_load_dwordx4 v22, s[28:31], s74 offen offset:2048 lds
    buffer_load_dwordx4 v23, s[28:31], s74 offen offset:3072 lds
    s_mul_i32 s75, s79, 196608
    s_add_u32 m0, s73, 89344
    s_add_u32 s74, s75, s76
    buffer_load_dwordx4 v24, s[32:35], s74 offen offset:0 lds
    buffer_load_dwordx4 v25, s[32:35], s74 offen offset:1024 lds
    s_add_u32 m0, s73, 97536
    s_add_u32 s74, s75, s77
    buffer_load_dwordx4 v24, s[36:39], s74 offen offset:0 lds
    buffer_load_dwordx4 v25, s[36:39], s74 offen offset:1024 lds
    s_add_u32 s79, s56, 7
    s_and_b32 s79, s79, 7
    s_xor_b32 s79, s79, s55
    s_lshl_b32 s74, s79, 7
    s_add_u32 m0, s72, 48384
    s_add_u32 s74, s74, s71
    s_waitcnt vmcnt(8)
    s_barrier
    buffer_load_dwordx4 v20, s[28:31], s74 offen offset:0 lds
    buffer_load_dwordx4 v21, s[28:31], s74 offen offset:1024 lds
    buffer_load_dwordx4 v22, s[28:31], s74 offen offset:2048 lds
    buffer_load_dwordx4 v23, s[28:31], s74 offen offset:3072 lds
    s_mul_i32 s75, s79, 196608
    s_add_u32 m0, s73, 105728
    s_add_u32 s74, s75, s76
    buffer_load_dwordx4 v24, s[32:35], s74 offen offset:0 lds
    buffer_load_dwordx4 v25, s[32:35], s74 offen offset:1024 lds
    s_add_u32 m0, s73, 113920
    s_add_u32 s74, s75, s77
    buffer_load_dwordx4 v24, s[36:39], s74 offen offset:0 lds
    buffer_load_dwordx4 v25, s[36:39], s74 offen offset:1024 lds
    s_add_u32 s79, s56, 5
    s_and_b32 s79, s79, 7
    s_xor_b32 s79, s79, s55
    s_mul_i32 s75, s79, 196608
    s_add_u32 m0, s73, 122112
    s_add_u32 s74, s75, s78
    buffer_load_dwordx4 v24, s[40:43], s74 offen offset:0 lds
    buffer_load_dwordx4 v25, s[40:43], s74 offen offset:1024 lds
    s_add_u32 s79, s56, 6
    s_and_b32 s79, s79, 7
    s_xor_b32 s79, s79, s55
    s_mul_i32 s75, s79, 196608
    s_add_u32 m0, s73, 130304
    s_add_u32 s74, s75, s78
    s_waitcnt vmcnt(10)
    s_barrier
    buffer_load_dwordx4 v24, s[40:43], s74 offen offset:0 lds
    buffer_load_dwordx4 v25, s[40:43], s74 offen offset:1024 lds
    s_add_u32 s79, s56, 7
    s_and_b32 s79, s79, 7
    s_xor_b32 s79, s79, s55
    s_mul_i32 s75, s79, 196608
    s_add_u32 m0, s73, 138496
    s_add_u32 s74, s75, s78
    buffer_load_dwordx4 v24, s[40:43], s74 offen offset:0 lds
    buffer_load_dwordx4 v25, s[40:43], s74 offen offset:1024 lds
    buffer_load_dwordx4 v[32:35], v17, s[28:31], s90 offen offset:0
    global_load_dwordx4 v[40:43], v16, s[18:19] offset:0
    buffer_load_dwordx4 v[36:39], v17, s[28:31], s90 offen offset:512
    global_load_dwordx4 v[44:47], v16, s[18:19] offset:512
    buffer_load_dword v48, v102, s[44:47], s91 offen nt
    buffer_load_dword v48, v243, s[44:47], s89 offen sc1
    s_waitcnt vmcnt(12)
    s_barrier
    ds_read_b64_tr_b16 v[136:137], v110 offset:26112
    ds_read_b64_tr_b16 v[138:139], v110 offset:26368
    ds_read_b64_tr_b16 v[140:141], v110 offset:26624
    ds_read_b64_tr_b16 v[142:143], v110 offset:26880
    v_add_u32 v249, 2, v249
    v_and_b32 v249, -2, v249
    v_not_b32 v240, v249
    s_waitcnt vmcnt(6)
    s_barrier
    s_waitcnt vmcnt(2)
    v_dot2_f32_bf16 v16, v32, v40, 0
    v_dot2_f32_bf16 v17, v33, v41, 0
    v_dot2_f32_bf16 v16, v34, v42, v16
    v_dot2_f32_bf16 v17, v35, v43, v17
    v_dot2_f32_bf16 v16, v36, v44, v16
    v_dot2_f32_bf16 v17, v37, v45, v17
    v_dot2_f32_bf16 v16, v38, v46, v16
    v_dot2_f32_bf16 v17, v39, v47, v17
    s_nop 2
    v_add_f32 v16, v16, v17
    s_nop 1
    v_add_f32_dpp v16, v16, v16 quad_perm:[1,0,3,2] row_mask:0xf bank_mask:0xf
    s_nop 1
    v_add_f32_dpp v16, v16, v16 quad_perm:[2,3,0,1] row_mask:0xf bank_mask:0xf
    s_nop 1
    v_add_f32_dpp v16, v16, v16 row_half_mirror row_mask:0xf bank_mask:0xf
    s_nop 1
    v_add_f32_dpp v16, v16, v16 row_mirror row_mask:0xf bank_mask:0xf
    s_nop 1
    v_add_f32_dpp v16, v16, v16 row_bcast:15 row_mask:0xa bank_mask:0xf
    v_mul_f32 v16, s68, v16
    v_exp_f32_e64 v16, -v16
    s_nop 0
    v_add_f32 v16, 1.0, v16
    v_rcp_f32 v248, v16
    s_barrier
    ds_read_b128 v[224:227], v109 offset:0
    ds_read_b128 v[228:231], v109 offset:1024
    ds_read_b128 v[192:195], v109 offset:8192
    ds_read_b128 v[196:199], v109 offset:9216
    buffer_load_dword v240, v243, s[44:47], s89 offen sc1
    s_waitcnt lgkmcnt(0)
    s_cmp_lg_u32 s84, 0
    s_cbranch_scc1 fz_kernel_fdonee
fz_kernel_fspine:
    v_cmp_ne_u32 vcc, v249, v240
    s_cbranch_vccz fz_kernel_foke
    s_mov_b64 exec, vcc
    buffer_load_dword v240, v243, s[44:47], s89 offen sc1
    s_mov_b64 exec, -1
    s_sub_u32 s85, s85, 1
    s_waitcnt vmcnt(2)
    s_cbranch_scc0 fz_kernel_fspine
fz_kernel_foke:
    s_mov_b32 s84, 1
    s_lshl_b32 m0, s3, 11
    s_add_u32 s64, s87, 3072
    buffer_load_dwordx4 v251, s[44:47], s87 offen nt lds
    buffer_load_dwordx4 v251, s[44:47], s64 offen offset:1024 nt lds
    s_add_u32 m0, s88, 64768
    s_add_u32 s64, s86, 0
    buffer_load_dwordx4 v251, s[44:47], s64 offen nt lds
    buffer_load_dwordx4 v251, s[44:47], s64 offen offset:1024 nt lds
    s_add_u32 m0, s88, 66832
    s_add_u32 s64, s86, 2048
    buffer_load_dwordx4 v251, s[44:47], s64 offen nt lds
    buffer_load_dwordx4 v251, s[44:47], s64 offen offset:1024 nt lds
    s_add_u32 m0, s88, 68896
    s_add_u32 s64, s86, 4096
    buffer_load_dwordx4 v251, s[44:47], s64 offen nt lds
    buffer_load_dwordx4 v251, s[44:47], s64 offen offset:1024 nt lds
    s_add_u32 m0, s88, 70960
    s_add_u32 s64, s86, 6144
    buffer_load_dwordx4 v251, s[44:47], s64 offen nt lds
    buffer_load_dwordx4 v251, s[44:47], s64 offen offset:1024 nt lds
fz_kernel_fdonee:
    s_branch fz_kernel_maps
fz_kernel_comp:
    s_and_b32 s65, s3, 2
    s_lshl2_add_u32 s58, s52, s65
    s_cmp_lt_u32 s3, 4
    s_addc_u32 s58, s58, 0
    s_lshl_b32 s57, s53, 4
    s_add_u32 s57, s57, s52
    s_lshl_b32 s57, s57, 10
    s_and_b32 s64, s2, 7
    s_lshl_b32 s64, s64, 2
    s_bfe_u32 s65, s2, 0x20003
    s_add_u32 s61, s64, s65
    s_lshr_b32 s62, s2, 5
    s_lshl_b32 s64, s62, 3
    s_add_u32 s64, s64, s3
    s_lshl_b32 s59, s64, 6
    s_add_u32 s59, s59, s61
    s_lshl_b32 s59, s59, 10
    s_add_u32 s59, s59, 0xd00000
    s_lshl_b32 s64, s62, 5
    s_add_u32 s64, s64, s61
    s_mul_i32 s64, s64, 1024
    s_mul_i32 s60, s3, 128
    s_add_u32 s60, s60, s64
    s_add_u32 s60, s60, 0x1140000
    s_mov_b32 s68, 0x3fb8aa3b
    s_mov_b32 s69, 0x3fb8aa3b
    s_lshl_b32 s64, s55, 1
    s_lshl_b32 s63, 1, s64
    s_and_b32 s65, s3, 4
    s_lshl2_add_u32 s63, s65, s63
    s_lshl3_add_u32 s64, s55, s3
    s_bitcmp1_b32 0x10, s64
    s_cselect_b32 s65, 2, 0
    s_or_b32 s63, s63, s65
    s_bitcmp1_b32 0x2020, s64
    s_cselect_b32 s65, 8, 0
    s_or_b32 s63, s63, s65
    s_cmp_eq_u32 s55, 0
    s_cselect_b32 s90, 0x3eb8aa3b, 1.0
    s_cselect_b64 vcc, -1, 0
    s_mov_b32 s91, s90
    s_mov_b32 s84, 1
    s_and_b32 s64, s58, 3
    s_lshl_b32 s64, s64, 9
    s_and_b32 s65, s3, 1
    s_lshl_b32 s94, s65, 6
    s_add_u32 s94, s94, s64
    s_mul_i32 s95, s65, 16512
    s_add_u32 s95, s95, s64
    s_add_u32 s95, s95, 15360
    s_lshr_b32 s64, s3, 1
    s_lshl_b32 s64, s64, 5
    s_mul_i32 s65, s65, 4128
    s_add_u32 s96, s64, s65
    s_mul_i32 s97, s3, 4128
    s_add_u32 s97, s97, 15360
    s_mov_b32 s26, 0xffff
    s_mov_b32 s27, 0xffff
    s_mov_b32 s85, 0
    s_mov_b32 s86, 0
    s_mov_b32 s87, 0
    s_mov_b32 s88, 0
    s_mov_b32 s89, 0
    v_and_b32 v144, 31, v250
    v_lshrrev_b32 v145, 5, v250
    v_bfe_u32 v146, v250, 1, 3
    v_xor_b32 v146, v146, v145
    s_and_b32 s64, s3, 2
    s_lshl_b32 s64, s64, 12
    s_add_u32 s64, s64, 32000
    v_lshl_add_u32 v147, v144, 7, s64
    v_xor_b32 v148, 0, v146
    v_lshl_add_u32 v240, v148, 4, v147
    v_xor_b32 v148, 2, v146
    v_lshl_add_u32 v241, v148, 4, v147
    v_xor_b32 v148, 4, v146
    v_lshl_add_u32 v242, v148, 4, v147
    v_xor_b32 v148, 6, v146
    v_lshl_add_u32 v243, v148, 4, v147
    s_and_b32 s77, s3, 1
    v_bfe_u32 v146, v250, 2, 2
    v_lshl_add_u32 v146, v145, 3, v146
    v_lshlrev_b32 v146, 7, v146
    v_bfe_u32 v149, v250, 3, 1
    v_xor_b32 v148, s77, v149
    v_lshl_add_u32 v146, v148, 6, v146
    v_bfe_u32 v147, v250, 4, 1
    v_lshl_add_u32 v146, v147, 5, v146
    v_and_b32 v148, 3, v250
    v_lshl_add_u32 v146, v148, 3, v146
    v_add_u32 v244, 81152, v146
    v_add_u32 v245, 146688, v146
    v_and_b32 v246, 0x33, v250
    v_bfe_u32 v146, v250, 2, 1
    v_lshl_or_b32 v246, v146, 3, v246
    v_lshl_or_b32 v246, v149, 2, v246
    v_lshlrev_b32 v246, 4, v246
    v_cndmask_b32 v246, v246, v251, vcc
    v_and_b32 v248, 15, v250
    v_lshlrev_b32 v248, 4, v248
    v_lshl_add_u32 v248, v145, 8, v248
    v_lshl_add_u32 v248, v147, 17, v248
    s_lshl_b32 s64, s3, 11
    v_add_u32 v252, s64, v251
    s_lshl1_add_u32 s64, s54, s77
    s_lshl_b32 s64, s64, 7
    s_add_u32 s64, s64, s58
    s_lshl_b32 s64, s64, 10
    s_lshl_b32 s64, s64, s55
    s_mul_i32 s65, s55, 0x200000
    s_add_u32 s72, s64, s65
    s_lshl_b32 s65, 0x10000, s55
    s_lshl_b32 s64, 0x400, s55
    s_add_u32 s73, s72, s65
    s_sub_u32 s70, s72, s64
    s_sub_u32 s71, s73, s64
    s_lshl_b32 s76, s3, 7
    s_add_u32 s76, s76, s57
    s_add_u32 s76, s76, 0x1100000
    s_and_b32 s64, s3, 1
    s_lshl_b32 s64, s64, 10
    v_lshrrev_b32 v253, 5, v250
    v_bfe_u32 v144, v250, 2, 2
    v_lshl_add_u32 v144, v253, 2, v144
    v_and_b32 v253, 3, v250
    v_lshl_add_u32 v253, v253, 3, s64
    v_lshl_add_u32 v253, v144, 5, v253
    s_add_u32 m0, s64, 26112
    s_lshl_b32 s77, s54, 11
    s_add_u32 s77, s77, s64
    s_getreg_b32 s78, hwreg(HW_REG_XCC_ID, 0, 4)
    s_lshl_b32 s78, s78, 8
    s_lshl_b32 s79, s54, 10
    s_add_u32 s79, s79, 0x1180400
    s_mov_b32 s64, 0x1180000
    s_waitcnt lgkmcnt(0)
    s_mov_b32 s48, s14
    s_mov_b32 s49, s15
    s_mov_b32 s50, 0x4000
    s_mov_b32 s51, 0x00020000
    s_mov_b32 s44, s24
    s_mov_b32 s45, s25
    s_mov_b32 s46, 0x1500000
    s_mov_b32 s47, 0x00020000
    buffer_load_dword v249, off, s[44:47], s64
    buffer_load_dwordx4 v251, s[48:51], s77 offen lds
    buffer_load_dword v247, off, s[44:47], s79
    v_lshrrev_b32 v146, 5, v250
    v_and_b32 v144, 31, v250
    v_lshlrev_b32 v145, 2, v146
    v_sub_u32 v144, v144, v145
    v_and_b32 v145, 1, v144
    v_lshlrev_b32 v145, 4, v145
    v_mov_b32 v128, 0x3f80
    v_lshlrev_b32 v145, v145, v128
    v_and_b32 v144, -2, v144
    v_cmp_eq_u32 vcc, 0, v144
    s_nop 1
    v_cndmask_b32 v128, 0, v145, vcc
    v_cmp_eq_u32 vcc, 2, v144
    s_nop 1
    v_cndmask_b32 v129, 0, v145, vcc
    v_cmp_eq_u32 vcc, 8, v144
    s_nop 1
    v_cndmask_b32 v130, 0, v145, vcc
    v_cmp_eq_u32 vcc, 10, v144
    s_nop 1
    v_cndmask_b32 v131, 0, v145, vcc
    v_cmp_eq_u32 vcc, 16, v144
    s_nop 1
    v_cndmask_b32 v132, 0, v145, vcc
    v_cmp_eq_u32 vcc, 18, v144
    s_nop 1
    v_cndmask_b32 v133, 0, v145, vcc
    v_cmp_eq_u32 vcc, 24, v144
    s_nop 1
    v_cndmask_b32 v134, 0, v145, vcc
    v_cmp_eq_u32 vcc, 26, v144
    s_nop 1
    v_cndmask_b32 v135, 0, v145, vcc
    s_barrier
    ds_read_b128 v[0:3], v240 offset:0
    ds_read_b64_tr_b16 v[96:97], v244 offset:32768
    ds_read_b64_tr_b16 v[98:99], v244 offset:33280
    ds_read_b128 v[4:7], v240 offset:4096
    ds_read_b128 v[8:11], v241 offset:0
    ds_read_b64_tr_b16 v[100:101], v244 offset:34816
    ds_read_b64_tr_b16 v[102:103], v244 offset:35328
    ds_read_b128 v[12:15], v241 offset:4096
    ds_read_b128 v[16:19], v242 offset:0
    ds_read_b64_tr_b16 v[104:105], v244 offset:36864
    ds_read_b64_tr_b16 v[106:107], v244 offset:37376
    ds_read_b128 v[20:23], v242 offset:4096
    ds_read_b128 v[24:27], v243 offset:0
    ds_read_b64_tr_b16 v[108:109], v244 offset:38912
    ds_read_b64_tr_b16 v[110:111], v244 offset:39424
    ds_read_b128 v[28:31], v243 offset:4096
    s_waitcnt lgkmcnt(13)
    v_mfma_f32_32x32x16_bf16 v[144:159], v[96:99], v[0:3], 0
    s_waitcnt lgkmcnt(12)
    v_mfma_f32_32x32x16_bf16 v[160:175], v[96:99], v[4:7], 0
    s_waitcnt lgkmcnt(9)
    v_mfma_f32_32x32x16_bf16 v[144:159], v[100:103], v[8:11], v[144:159]
    s_waitcnt lgkmcnt(8)
    v_mfma_f32_32x32x16_bf16 v[160:175], v[100:103], v[12:15], v[160:175]
    s_waitcnt lgkmcnt(5)
    v_mfma_f32_32x32x16_bf16 v[144:159], v[104:107], v[16:19], v[144:159]
    s_barrier
    ds_read_b64_tr_b16 v[112:113], v244 offset:40960
    ds_read_b64_tr_b16 v[114:115], v244 offset:41472
    ds_read_b64_tr_b16 v[116:117], v244 offset:43008
    ds_read_b64_tr_b16 v[118:119], v244 offset:43520
    ds_read_b64_tr_b16 v[120:121], v244 offset:45056
    ds_read_b64_tr_b16 v[122:123], v244 offset:45568
    s_waitcnt lgkmcnt(10)
    v_mfma_f32_32x32x16_bf16 v[160:175], v[104:107], v[20:23], v[160:175]
    s_waitcnt lgkmcnt(7)
    v_mfma_f32_32x32x16_bf16 v[144:159], v[108:111], v[24:27], v[144:159]
    ds_read_b64_tr_b16 v[124:125], v244 offset:47104
    ds_read_b64_tr_b16 v[126:127], v244 offset:47616
    s_waitcnt lgkmcnt(8)
    v_mfma_f32_32x32x16_bf16 v[160:175], v[108:111], v[28:31], v[160:175]
    s_waitcnt lgkmcnt(6)
    v_mfma_f32_32x32x16_bf16 v[176:191], v[0:3], v[112:115], 0
    ds_read_b64_tr_b16 v[96:97], v244 offset:49152
    ds_read_b64_tr_b16 v[98:99], v244 offset:49664
    v_mfma_f32_32x32x16_bf16 v[192:207], v[4:7], v[112:115], 0
    s_waitcnt lgkmcnt(6)
    v_mfma_f32_32x32x16_bf16 v[176:191], v[8:11], v[116:119], v[176:191]
    ds_read_b64_tr_b16 v[100:101], v244 offset:51200
    ds_read_b64_tr_b16 v[102:103], v244 offset:51712
    v_mfma_f32_32x32x16_bf16 v[192:207], v[12:15], v[116:119], v[192:207]
    s_waitcnt lgkmcnt(6)
    v_mfma_f32_32x32x16_bf16 v[176:191], v[16:19], v[120:123], v[176:191]
    ds_read_b64_tr_b16 v[104:105], v244 offset:53248
    ds_read_b64_tr_b16 v[106:107], v244 offset:53760
    v_mfma_f32_32x32x16_bf16 v[192:207], v[20:23], v[120:123], v[192:207]
    s_waitcnt lgkmcnt(6)
    v_mfma_f32_32x32x16_bf16 v[176:191], v[24:27], v[124:127], v[176:191]
    ds_read_b64_tr_b16 v[108:109], v244 offset:55296
    ds_read_b64_tr_b16 v[110:111], v244 offset:55808
    v_mfma_f32_32x32x16_bf16 v[192:207], v[28:31], v[124:127], v[192:207]
    s_waitcnt lgkmcnt(6)
    v_mfma_f32_32x32x16_bf16 v[208:223], v[96:99], v[0:3], 0
    s_barrier
    ds_read_b128 v[32:35], v240 offset:16384
    ds_read_b64_tr_b16 v[112:113], v244 offset:57344
    ds_read_b64_tr_b16 v[114:115], v244 offset:57856
    v_mfma_f32_32x32x16_bf16 v[224:239], v[96:99], v[4:7], 0
    ds_read_b128 v[36:39], v240 offset:20480
    s_waitcnt lgkmcnt(8)
    v_mfma_f32_32x32x16_bf16 v[208:223], v[100:103], v[8:11], v[208:223]
    ds_read_b128 v[40:43], v241 offset:16384
    ds_read_b64_tr_b16 v[116:117], v244 offset:59392
    ds_read_b64_tr_b16 v[118:119], v244 offset:59904
    v_mfma_f32_32x32x16_bf16 v[224:239], v[100:103], v[12:15], v[224:239]
    ds_read_b128 v[44:47], v241 offset:20480
    s_waitcnt lgkmcnt(10)
    v_mfma_f32_32x32x16_bf16 v[208:223], v[104:107], v[16:19], v[208:223]
    ds_read_b128 v[48:51], v242 offset:16384
    ds_read_b64_tr_b16 v[120:121], v244 offset:61440
    ds_read_b64_tr_b16 v[122:123], v244 offset:61952
    v_mfma_f32_32x32x16_bf16 v[224:239], v[104:107], v[20:23], v[224:239]
    ds_read_b128 v[52:55], v242 offset:20480
    s_waitcnt lgkmcnt(12)
    v_mfma_f32_32x32x16_bf16 v[208:223], v[108:111], v[24:27], v[208:223]
    ds_read_b128 v[56:59], v243 offset:16384
    ds_read_b64_tr_b16 v[124:125], v244 offset:63488
    ds_read_b64_tr_b16 v[126:127], v244 offset:64000
    v_mfma_f32_32x32x16_bf16 v[224:239], v[108:111], v[28:31], v[224:239]
    ds_read_b128 v[60:63], v243 offset:20480
    s_waitcnt lgkmcnt(13)
    v_mfma_f32_32x32x16_bf16 v[144:159], v[112:115], v[32:35], v[144:159]
    ds_read_b64_tr_b16 v[96:97], v245 offset:0
    ds_read_b64_tr_b16 v[98:99], v245 offset:512
    s_waitcnt lgkmcnt(14)
    v_mfma_f32_32x32x16_bf16 v[160:175], v[112:115], v[36:39], v[160:175]
    s_waitcnt lgkmcnt(11)
    v_mfma_f32_32x32x16_bf16 v[144:159], v[116:119], v[40:43], v[144:159]
    ds_read_b64_tr_b16 v[100:101], v245 offset:2048
    ds_read_b64_tr_b16 v[102:103], v245 offset:2560
    s_waitcnt lgkmcnt(12)
    v_mfma_f32_32x32x16_bf16 v[160:175], v[116:119], v[44:47], v[160:175]
    s_waitcnt lgkmcnt(9)
    v_mfma_f32_32x32x16_bf16 v[144:159], v[120:123], v[48:51], v[144:159]
    ds_read_b64_tr_b16 v[104:105], v245 offset:4096
    ds_read_b64_tr_b16 v[106:107], v245 offset:4608
    s_waitcnt lgkmcnt(10)
    v_mfma_f32_32x32x16_bf16 v[160:175], v[120:123], v[52:55], v[160:175]
    s_waitcnt lgkmcnt(7)
    v_mfma_f32_32x32x16_bf16 v[144:159], v[124:127], v[56:59], v[144:159]
    ds_read_b64_tr_b16 v[108:109], v245 offset:6144
    ds_read_b64_tr_b16 v[110:111], v245 offset:6656
    s_waitcnt lgkmcnt(8)
    v_mfma_f32_32x32x16_bf16 v[160:175], v[124:127], v[60:63], v[160:175]
    s_waitcnt lgkmcnt(6)
    v_mfma_f32_32x32x16_bf16 v[176:191], v[32:35], v[96:99], v[176:191]
    ds_read_b64_tr_b16 v[112:113], v245 offset:8192
    ds_read_b64_tr_b16 v[114:115], v245 offset:8704
    v_mfma_f32_32x32x16_bf16 v[192:207], v[36:39], v[96:99], v[192:207]
    s_waitcnt lgkmcnt(6)
    v_mfma_f32_32x32x16_bf16 v[176:191], v[40:43], v[100:103], v[176:191]
    ds_read_b64_tr_b16 v[116:117], v245 offset:10240
    ds_read_b64_tr_b16 v[118:119], v245 offset:10752
    v_mfma_f32_32x32x16_bf16 v[192:207], v[44:47], v[100:103], v[192:207]
    s_waitcnt lgkmcnt(6)
    v_mfma_f32_32x32x16_bf16 v[176:191], v[48:51], v[104:107], v[176:191]
    ds_read_b64_tr_b16 v[120:121], v245 offset:12288
    ds_read_b64_tr_b16 v[122:123], v245 offset:12800
    v_mfma_f32_32x32x16_bf16 v[192:207], v[52:55], v[104:107], v[192:207]
    s_waitcnt lgkmcnt(6)
    v_mfma_f32_32x32x16_bf16 v[176:191], v[56:59], v[108:111], v[176:191]
    ds_read_b64_tr_b16 v[124:125], v245 offset:14336
    ds_read_b64_tr_b16 v[126:127], v245 offset:14848
    v_mfma_f32_32x32x16_bf16 v[192:207], v[60:63], v[108:111], v[192:207]
    s_waitcnt lgkmcnt(6)
    v_mfma_f32_32x32x16_bf16 v[208:223], v[112:115], v[32:35], v[208:223]
    s_lshr_b32 s64, s2, 1
    s_and_b32 s64, s64, 0x7c
    s_add_u32 s64, s64, s79
    s_cmp_lg_u32 s3, 0
    s_waitcnt vmcnt(0)
    v_add_u32 v249, 2, v249
    v_and_b32 v249, -2, v249
    v_xor_b32 v254, s78, v249
    s_cbranch_scc1 fz_kernel_noat
    s_mov_b64 exec, 1
    buffer_store_dword v254, off, s[44:47], s64
    s_mov_b64 exec, -1
fz_kernel_noat:
    s_barrier
    ds_read_b128 v[64:67], v240 offset:32768
    ds_read_b64_tr_b16 v[96:97], v244 offset:0
    ds_read_b64_tr_b16 v[98:99], v244 offset:512
    v_mfma_f32_32x32x16_bf16 v[224:239], v[112:115], v[36:39], v[224:239]
    ds_read_b128 v[68:71], v240 offset:36864
    s_waitcnt lgkmcnt(8)
    v_mfma_f32_32x32x16_bf16 v[208:223], v[116:119], v[40:43], v[208:223]
    ds_read_b128 v[72:75], v241 offset:32768
    ds_read_b64_tr_b16 v[100:101], v244 offset:2048
    ds_read_b64_tr_b16 v[102:103], v244 offset:2560
    v_mfma_f32_32x32x16_bf16 v[224:239], v[116:119], v[44:47], v[224:239]
    ds_read_b128 v[76:79], v241 offset:36864
    s_waitcnt lgkmcnt(10)
    v_mfma_f32_32x32x16_bf16 v[208:223], v[120:123], v[48:51], v[208:223]
    ds_read_b128 v[80:83], v242 offset:32768
    ds_read_b64_tr_b16 v[104:105], v244 offset:4096
    ds_read_b64_tr_b16 v[106:107], v244 offset:4608
    v_mfma_f32_32x32x16_bf16 v[224:239], v[120:123], v[52:55], v[224:239]
    ds_read_b128 v[84:87], v242 offset:36864
    s_waitcnt lgkmcnt(12)
    v_mfma_f32_32x32x16_bf16 v[208:223], v[124:127], v[56:59], v[208:223]
    ds_read_b128 v[88:91], v243 offset:32768
    ds_read_b64_tr_b16 v[108:109], v244 offset:6144
    ds_read_b64_tr_b16 v[110:111], v244 offset:6656
    v_mfma_f32_32x32x16_bf16 v[224:239], v[124:127], v[60:63], v[224:239]
    ds_read_b128 v[92:95], v243 offset:36864
    s_waitcnt lgkmcnt(13)
    v_mfma_f32_32x32x16_bf16 v[144:159], v[96:99], v[64:67], v[144:159]
    ds_read_b64_tr_b16 v[112:113], v244 offset:8192
    ds_read_b64_tr_b16 v[114:115], v244 offset:8704
    s_waitcnt lgkmcnt(14)
    v_mfma_f32_32x32x16_bf16 v[160:175], v[96:99], v[68:71], v[160:175]
    s_waitcnt lgkmcnt(11)
    v_mfma_f32_32x32x16_bf16 v[144:159], v[100:103], v[72:75], v[144:159]
    ds_read_b64_tr_b16 v[116:117], v244 offset:10240
    ds_read_b64_tr_b16 v[118:119], v244 offset:10752
    s_waitcnt lgkmcnt(12)
    v_mfma_f32_32x32x16_bf16 v[160:175], v[100:103], v[76:79], v[160:175]
    s_waitcnt lgkmcnt(9)
    v_mfma_f32_32x32x16_bf16 v[144:159], v[104:107], v[80:83], v[144:159]
    ds_read_b64_tr_b16 v[120:121], v244 offset:12288
    ds_read_b64_tr_b16 v[122:123], v244 offset:12800
    s_waitcnt lgkmcnt(10)
    v_mfma_f32_32x32x16_bf16 v[160:175], v[104:107], v[84:87], v[160:175]
    s_waitcnt lgkmcnt(7)
    v_mfma_f32_32x32x16_bf16 v[144:159], v[108:111], v[88:91], v[144:159]
    ds_read_b64_tr_b16 v[124:125], v244 offset:14336
    ds_read_b64_tr_b16 v[126:127], v244 offset:14848
    s_waitcnt lgkmcnt(8)
    v_mfma_f32_32x32x16_bf16 v[160:175], v[108:111], v[92:95], v[160:175]
    s_waitcnt lgkmcnt(6)
    v_mfma_f32_32x32x16_bf16 v[176:191], v[64:67], v[112:115], v[176:191]
    ds_read_b64_tr_b16 v[96:97], v244 offset:16384
    ds_read_b64_tr_b16 v[98:99], v244 offset:16896
    v_mfma_f32_32x32x16_bf16 v[192:207], v[68:71], v[112:115], v[192:207]
    s_waitcnt lgkmcnt(6)
    v_mfma_f32_32x32x16_bf16 v[176:191], v[72:75], v[116:119], v[176:191]
    ds_read_b64_tr_b16 v[100:101], v244 offset:18432
    ds_read_b64_tr_b16 v[102:103], v244 offset:18944
    v_mfma_f32_32x32x16_bf16 v[192:207], v[76:79], v[116:119], v[192:207]
    s_waitcnt lgkmcnt(6)
    v_mfma_f32_32x32x16_bf16 v[176:191], v[80:83], v[120:123], v[176:191]
    ds_read_b64_tr_b16 v[104:105], v244 offset:20480
    ds_read_b64_tr_b16 v[106:107], v244 offset:20992
    v_mfma_f32_32x32x16_bf16 v[192:207], v[84:87], v[120:123], v[192:207]
    s_waitcnt lgkmcnt(6)
    v_mfma_f32_32x32x16_bf16 v[176:191], v[88:91], v[124:127], v[176:191]
    ds_read_b64_tr_b16 v[108:109], v244 offset:22528
    ds_read_b64_tr_b16 v[110:111], v244 offset:23040
    v_mfma_f32_32x32x16_bf16 v[192:207], v[92:95], v[124:127], v[192:207]
    s_waitcnt lgkmcnt(6)
    v_mfma_f32_32x32x16_bf16 v[208:223], v[96:99], v[64:67], v[208:223]
    s_barrier
    ds_read_b128 v[0:3], v240 offset:0
    ds_read_b64_tr_b16 v[112:113], v244 offset:24576
    ds_read_b64_tr_b16 v[114:115], v244 offset:25088
    v_mfma_f32_32x32x16_bf16 v[224:239], v[96:99], v[68:71], v[224:239]
    ds_read_b128 v[4:7], v240 offset:4096
    s_waitcnt lgkmcnt(8)
    v_mfma_f32_32x32x16_bf16 v[208:223], v[100:103], v[72:75], v[208:223]
    ds_read_b128 v[8:11], v241 offset:0
    ds_read_b64_tr_b16 v[116:117], v244 offset:26624
    ds_read_b64_tr_b16 v[118:119], v244 offset:27136
    v_mfma_f32_32x32x16_bf16 v[224:239], v[100:103], v[76:79], v[224:239]
    ds_read_b128 v[12:15], v241 offset:4096
    s_waitcnt lgkmcnt(10)
    v_mfma_f32_32x32x16_bf16 v[208:223], v[104:107], v[80:83], v[208:223]
    ds_read_b128 v[16:19], v242 offset:0
    ds_read_b64_tr_b16 v[120:121], v244 offset:28672
    ds_read_b64_tr_b16 v[122:123], v244 offset:29184
    v_mfma_f32_32x32x16_bf16 v[224:239], v[104:107], v[84:87], v[224:239]
    ds_read_b128 v[20:23], v242 offset:4096
    s_waitcnt lgkmcnt(12)
    v_mfma_f32_32x32x16_bf16 v[208:223], v[108:111], v[88:91], v[208:223]
    ds_read_b128 v[24:27], v243 offset:0
    ds_read_b64_tr_b16 v[124:125], v244 offset:30720
    ds_read_b64_tr_b16 v[126:127], v244 offset:31232
    v_mfma_f32_32x32x16_bf16 v[224:239], v[108:111], v[92:95], v[224:239]
    ds_read_b128 v[28:31], v243 offset:4096
    s_waitcnt lgkmcnt(13)
    v_mfma_f32_32x32x16_bf16 v[144:159], v[112:115], v[0:3], v[144:159]
    ds_read_b64_tr_b16 v[96:97], v244 offset:32768
    ds_read_b64_tr_b16 v[98:99], v244 offset:33280
    s_waitcnt lgkmcnt(14)
    v_mfma_f32_32x32x16_bf16 v[160:175], v[112:115], v[4:7], v[160:175]
    s_waitcnt lgkmcnt(11)
    v_mfma_f32_32x32x16_bf16 v[144:159], v[116:119], v[8:11], v[144:159]
    ds_read_b64_tr_b16 v[100:101], v244 offset:34816
    ds_read_b64_tr_b16 v[102:103], v244 offset:35328
    s_waitcnt lgkmcnt(12)
    v_mfma_f32_32x32x16_bf16 v[160:175], v[116:119], v[12:15], v[160:175]
    s_waitcnt lgkmcnt(9)
    v_mfma_f32_32x32x16_bf16 v[144:159], v[120:123], v[16:19], v[144:159]
    ds_read_b64_tr_b16 v[104:105], v244 offset:36864
    ds_read_b64_tr_b16 v[106:107], v244 offset:37376
    s_waitcnt lgkmcnt(10)
    v_mfma_f32_32x32x16_bf16 v[160:175], v[120:123], v[20:23], v[160:175]
    s_waitcnt lgkmcnt(7)
    v_mfma_f32_32x32x16_bf16 v[144:159], v[124:127], v[24:27], v[144:159]
    ds_read_b64_tr_b16 v[108:109], v244 offset:38912
    ds_read_b64_tr_b16 v[110:111], v244 offset:39424
    s_waitcnt lgkmcnt(8)
    v_mfma_f32_32x32x16_bf16 v[160:175], v[124:127], v[28:31], v[160:175]
    s_waitcnt lgkmcnt(6)
    v_mfma_f32_32x32x16_bf16 v[176:191], v[0:3], v[96:99], v[176:191]
    ds_read_b64_tr_b16 v[112:113], v244 offset:40960
    ds_read_b64_tr_b16 v[114:115], v244 offset:41472
    v_mfma_f32_32x32x16_bf16 v[192:207], v[4:7], v[96:99], v[192:207]
    s_waitcnt lgkmcnt(6)
    v_mfma_f32_32x32x16_bf16 v[176:191], v[8:11], v[100:103], v[176:191]
    ds_read_b64_tr_b16 v[116:117], v244 offset:43008
    ds_read_b64_tr_b16 v[118:119], v244 offset:43520
    v_mfma_f32_32x32x16_bf16 v[192:207], v[12:15], v[100:103], v[192:207]
    s_waitcnt lgkmcnt(6)
    v_mfma_f32_32x32x16_bf16 v[176:191], v[16:19], v[104:107], v[176:191]
    ds_read_b64_tr_b16 v[120:121], v244 offset:45056
    ds_read_b64_tr_b16 v[122:123], v244 offset:45568
    v_mfma_f32_32x32x16_bf16 v[192:207], v[20:23], v[104:107], v[192:207]
    s_waitcnt lgkmcnt(6)
    v_mfma_f32_32x32x16_bf16 v[176:191], v[24:27], v[108:111], v[176:191]
    ds_read_b64_tr_b16 v[124:125], v244 offset:47104
    ds_read_b64_tr_b16 v[126:127], v244 offset:47616
    v_mfma_f32_32x32x16_bf16 v[192:207], v[28:31], v[108:111], v[192:207]
    s_waitcnt lgkmcnt(6)
    v_mfma_f32_32x32x16_bf16 v[208:223], v[112:115], v[0:3], v[208:223]
    s_barrier
    ds_read_b128 v[32:35], v240 offset:16384
    ds_read_b64_tr_b16 v[96:97], v244 offset:49152
    ds_read_b64_tr_b16 v[98:99], v244 offset:49664
    v_mfma_f32_32x32x16_bf16 v[224:239], v[112:115], v[4:7], v[224:239]
    ds_read_b128 v[36:39], v240 offset:20480
    s_waitcnt lgkmcnt(8)
    v_mfma_f32_32x32x16_bf16 v[208:223], v[116:119], v[8:11], v[208:223]
    ds_read_b128 v[40:43], v241 offset:16384
    ds_read_b64_tr_b16 v[100:101], v244 offset:51200
    ds_read_b64_tr_b16 v[102:103], v244 offset:51712
    v_mfma_f32_32x32x16_bf16 v[224:239], v[116:119], v[12:15], v[224:239]
    ds_read_b128 v[44:47], v241 offset:20480
    s_waitcnt lgkmcnt(10)
    v_mfma_f32_32x32x16_bf16 v[208:223], v[120:123], v[16:19], v[208:223]
    ds_read_b128 v[48:51], v242 offset:16384
    ds_read_b64_tr_b16 v[104:105], v244 offset:53248
    ds_read_b64_tr_b16 v[106:107], v244 offset:53760
    v_mfma_f32_32x32x16_bf16 v[224:239], v[120:123], v[20:23], v[224:239]
    ds_read_b128 v[52:55], v242 offset:20480
    s_waitcnt lgkmcnt(12)
    v_mfma_f32_32x32x16_bf16 v[208:223], v[124:127], v[24:27], v[208:223]
    ds_read_b128 v[56:59], v243 offset:16384
    ds_read_b64_tr_b16 v[108:109], v244 offset:55296
    ds_read_b64_tr_b16 v[110:111], v244 offset:55808
    v_mfma_f32_32x32x16_bf16 v[224:239], v[124:127], v[28:31], v[224:239]
    ds_read_b128 v[60:63], v243 offset:20480
    s_waitcnt lgkmcnt(13)
    v_mfma_f32_32x32x16_bf16 v[144:159], v[96:99], v[32:35], v[144:159]
    ds_read_b64_tr_b16 v[112:113], v244 offset:57344
    ds_read_b64_tr_b16 v[114:115], v244 offset:57856
    s_waitcnt lgkmcnt(14)
    v_mfma_f32_32x32x16_bf16 v[160:175], v[96:99], v[36:39], v[160:175]
    s_waitcnt lgkmcnt(11)
    v_mfma_f32_32x32x16_bf16 v[144:159], v[100:103], v[40:43], v[144:159]
    ds_read_b64_tr_b16 v[116:117], v244 offset:59392
    ds_read_b64_tr_b16 v[118:119], v244 offset:59904
    s_waitcnt lgkmcnt(12)
    v_mfma_f32_32x32x16_bf16 v[160:175], v[100:103], v[44:47], v[160:175]
    s_waitcnt lgkmcnt(9)
    v_mfma_f32_32x32x16_bf16 v[144:159], v[104:107], v[48:51], v[144:159]
    ds_read_b64_tr_b16 v[120:121], v244 offset:61440
    ds_read_b64_tr_b16 v[122:123], v244 offset:61952
    s_waitcnt lgkmcnt(10)
    v_mfma_f32_32x32x16_bf16 v[160:175], v[104:107], v[52:55], v[160:175]
    s_waitcnt lgkmcnt(7)
    v_mfma_f32_32x32x16_bf16 v[144:159], v[108:111], v[56:59], v[144:159]
    ds_read_b64_tr_b16 v[124:125], v244 offset:63488
    ds_read_b64_tr_b16 v[126:127], v244 offset:64000
    s_waitcnt lgkmcnt(8)
    v_mfma_f32_32x32x16_bf16 v[160:175], v[108:111], v[60:63], v[160:175]
    s_waitcnt lgkmcnt(6)
    v_mfma_f32_32x32x16_bf16 v[176:191], v[32:35], v[112:115], v[176:191]
    ds_read_b64_tr_b16 v[96:97], v245 offset:0
    ds_read_b64_tr_b16 v[98:99], v245 offset:512
    v_mfma_f32_32x32x16_bf16 v[192:207], v[36:39], v[112:115], v[192:207]
    s_waitcnt lgkmcnt(6)
    v_mfma_f32_32x32x16_bf16 v[176:191], v[40:43], v[116:119], v[176:191]
    ds_read_b64_tr_b16 v[100:101], v245 offset:2048
    ds_read_b64_tr_b16 v[102:103], v245 offset:2560
    v_mfma_f32_32x32x16_bf16 v[192:207], v[44:47], v[116:119], v[192:207]
    s_waitcnt lgkmcnt(6)
    v_mfma_f32_32x32x16_bf16 v[176:191], v[48:51], v[120:123], v[176:191]
    ds_read_b64_tr_b16 v[104:105], v245 offset:4096
    ds_read_b64_tr_b16 v[106:107], v245 offset:4608
    v_mfma_f32_32x32x16_bf16 v[192:207], v[52:55], v[120:123], v[192:207]
    s_waitcnt lgkmcnt(6)
    v_mfma_f32_32x32x16_bf16 v[176:191], v[56:59], v[124:127], v[176:191]
    ds_read_b64_tr_b16 v[108:109], v245 offset:6144
    ds_read_b64_tr_b16 v[110:111], v245 offset:6656
    v_mfma_f32_32x32x16_bf16 v[192:207], v[60:63], v[124:127], v[192:207]
    s_waitcnt lgkmcnt(6)
    v_mfma_f32_32x32x16_bf16 v[208:223], v[96:99], v[32:35], v[208:223]
    s_barrier
    ds_read_b128 v[64:67], v240 offset:32768
    ds_read_b64_tr_b16 v[112:113], v245 offset:8192
    ds_read_b64_tr_b16 v[114:115], v245 offset:8704
    v_mfma_f32_32x32x16_bf16 v[224:239], v[96:99], v[36:39], v[224:239]
    ds_read_b128 v[68:71], v240 offset:36864
    s_waitcnt lgkmcnt(8)
    v_mfma_f32_32x32x16_bf16 v[208:223], v[100:103], v[40:43], v[208:223]
    ds_read_b128 v[72:75], v241 offset:32768
    ds_read_b64_tr_b16 v[116:117], v245 offset:10240
    ds_read_b64_tr_b16 v[118:119], v245 offset:10752
    v_mfma_f32_32x32x16_bf16 v[224:239], v[100:103], v[44:47], v[224:239]
    ds_read_b128 v[76:79], v241 offset:36864
    s_waitcnt lgkmcnt(10)
    v_mfma_f32_32x32x16_bf16 v[208:223], v[104:107], v[48:51], v[208:223]
    ds_read_b128 v[80:83], v242 offset:32768
    ds_read_b64_tr_b16 v[120:121], v245 offset:12288
    ds_read_b64_tr_b16 v[122:123], v245 offset:12800
    v_mfma_f32_32x32x16_bf16 v[224:239], v[104:107], v[52:55], v[224:239]
    ds_read_b128 v[84:87], v242 offset:36864
    s_waitcnt lgkmcnt(12)
    v_mfma_f32_32x32x16_bf16 v[208:223], v[108:111], v[56:59], v[208:223]
    ds_read_b128 v[88:91], v243 offset:32768
    ds_read_b64_tr_b16 v[124:125], v245 offset:14336
    ds_read_b64_tr_b16 v[126:127], v245 offset:14848
    v_mfma_f32_32x32x16_bf16 v[224:239], v[108:111], v[60:63], v[224:239]
    ds_read_b128 v[92:95], v243 offset:36864
    s_waitcnt lgkmcnt(13)
    v_mfma_f32_32x32x16_bf16 v[144:159], v[112:115], v[64:67], v[144:159]
    ds_read_b64_tr_b16 v[96:97], v244 offset:0
    ds_read_b64_tr_b16 v[98:99], v244 offset:512
    s_waitcnt lgkmcnt(14)
    v_mfma_f32_32x32x16_bf16 v[160:175], v[112:115], v[68:71], v[160:175]
    s_waitcnt lgkmcnt(11)
    v_mfma_f32_32x32x16_bf16 v[144:159], v[116:119], v[72:75], v[144:159]
    ds_read_b64_tr_b16 v[100:101], v244 offset:2048
    ds_read_b64_tr_b16 v[102:103], v244 offset:2560
    s_waitcnt lgkmcnt(12)
    v_mfma_f32_32x32x16_bf16 v[160:175], v[116:119], v[76:79], v[160:175]
    s_waitcnt lgkmcnt(9)
    v_mfma_f32_32x32x16_bf16 v[144:159], v[120:123], v[80:83], v[144:159]
    ds_read_b64_tr_b16 v[104:105], v244 offset:4096
    ds_read_b64_tr_b16 v[106:107], v244 offset:4608
    s_waitcnt lgkmcnt(10)
    v_mfma_f32_32x32x16_bf16 v[160:175], v[120:123], v[84:87], v[160:175]
    s_waitcnt lgkmcnt(7)
    v_mfma_f32_32x32x16_bf16 v[144:159], v[124:127], v[88:91], v[144:159]
    ds_read_b64_tr_b16 v[108:109], v244 offset:6144
    ds_read_b64_tr_b16 v[110:111], v244 offset:6656
    s_waitcnt lgkmcnt(8)
    v_mfma_f32_32x32x16_bf16 v[160:175], v[124:127], v[92:95], v[160:175]
    s_waitcnt lgkmcnt(6)
    v_mfma_f32_32x32x16_bf16 v[176:191], v[64:67], v[96:99], v[176:191]
    ds_read_b64_tr_b16 v[136:137], v253 offset:26112
    s_barrier
    ds_read_b128 v[0:3], v240 offset:0
    ds_read_b64_tr_b16 v[112:113], v244 offset:8192
    ds_read_b64_tr_b16 v[114:115], v244 offset:8704
    v_mfma_f32_32x32x16_bf16 v[192:207], v[68:71], v[96:99], v[192:207]
    ds_read_b64_tr_b16 v[138:139], v253 offset:26368
    ds_read_b128 v[4:7], v240 offset:4096
    s_waitcnt lgkmcnt(10)
    v_mfma_f32_32x32x16_bf16 v[176:191], v[72:75], v[100:103], v[176:191]
    ds_read_b64_tr_b16 v[140:141], v253 offset:26624
    ds_read_b128 v[8:11], v241 offset:0
    ds_read_b64_tr_b16 v[116:117], v244 offset:10240
    ds_read_b64_tr_b16 v[118:119], v244 offset:10752
    v_mfma_f32_32x32x16_bf16 v[192:207], v[76:79], v[100:103], v[192:207]
    ds_read_b64_tr_b16 v[142:143], v253 offset:26880
    ds_read_b128 v[12:15], v241 offset:4096
    s_waitcnt lgkmcnt(14)
    v_mfma_f32_32x32x16_bf16 v[176:191], v[80:83], v[104:107], v[176:191]
    ds_read_b128 v[16:19], v242 offset:0
    ds_read_b64_tr_b16 v[120:121], v244 offset:12288
    ds_read_b64_tr_b16 v[122:123], v244 offset:12800
    v_mfma_f32_32x32x16_bf16 v[192:207], v[84:87], v[104:107], v[192:207]
    ds_read_b128 v[20:23], v242 offset:4096
    s_waitcnt lgkmcnt(15)
    v_mfma_f32_32x32x16_bf16 v[176:191], v[88:91], v[108:111], v[176:191]
    ds_read_b128 v[24:27], v243 offset:0
    ds_read_b64_tr_b16 v[124:125], v244 offset:14336
    ds_read_b64_tr_b16 v[126:127], v244 offset:14848
    v_mfma_f32_32x32x16_bf16 v[192:207], v[92:95], v[108:111], v[192:207]
    ds_read_b128 v[28:31], v243 offset:4096
    s_waitcnt lgkmcnt(15)
    v_mfma_f32_32x32x16_bf16 v[144:159], v[112:115], v[0:3], v[144:159]
    ds_read_b64_tr_b16 v[96:97], v244 offset:16384
    ds_read_b64_tr_b16 v[98:99], v244 offset:16896
    s_waitcnt lgkmcnt(15)
    v_mfma_f32_32x32x16_bf16 v[160:175], v[112:115], v[4:7], v[160:175]
    s_waitcnt lgkmcnt(12)
    v_mfma_f32_32x32x16_bf16 v[144:159], v[116:119], v[8:11], v[144:159]
    ds_read_b64_tr_b16 v[100:101], v244 offset:18432
    ds_read_b64_tr_b16 v[102:103], v244 offset:18944
    s_waitcnt lgkmcnt(12)
    v_mfma_f32_32x32x16_bf16 v[160:175], v[116:119], v[12:15], v[160:175]
    s_waitcnt lgkmcnt(9)
    v_mfma_f32_32x32x16_bf16 v[144:159], v[120:123], v[16:19], v[144:159]
    ds_read_b64_tr_b16 v[104:105], v244 offset:20480
    ds_read_b64_tr_b16 v[106:107], v244 offset:20992
    s_waitcnt lgkmcnt(10)
    v_mfma_f32_32x32x16_bf16 v[160:175], v[120:123], v[20:23], v[160:175]
    s_waitcnt lgkmcnt(7)
    v_mfma_f32_32x32x16_bf16 v[144:159], v[124:127], v[24:27], v[144:159]
    ds_read_b64_tr_b16 v[108:109], v244 offset:22528
    ds_read_b64_tr_b16 v[110:111], v244 offset:23040
    s_waitcnt lgkmcnt(8)
    v_mfma_f32_32x32x16_bf16 v[160:175], v[124:127], v[28:31], v[160:175]
    s_waitcnt lgkmcnt(6)
    v_mfma_f32_32x32x16_bf16 v[176:191], v[0:3], v[96:99], v[176:191]
    v_bfe_u32 v247, v251, 2, 7
    buffer_load_dword v247, v247, s[44:47], s79 offen sc1
    s_barrier
    ds_read_b128 v[32:35], v240 offset:16384
    ds_read_b64_tr_b16 v[112:113], v244 offset:24576
    ds_read_b64_tr_b16 v[114:115], v244 offset:25088
    v_mfma_f32_32x32x16_bf16 v[192:207], v[4:7], v[96:99], v[192:207]
    ds_read_b128 v[40:43], v241 offset:16384
    ds_read_b64_tr_b16 v[116:117], v244 offset:26624
    ds_read_b64_tr_b16 v[118:119], v244 offset:27136
    s_waitcnt lgkmcnt(10)
    v_mfma_f32_32x32x16_bf16 v[176:191], v[8:11], v[100:103], v[176:191]
    ds_read_b128 v[48:51], v242 offset:16384
    ds_read_b64_tr_b16 v[120:121], v244 offset:28672
    ds_read_b64_tr_b16 v[122:123], v244 offset:29184
    v_mfma_f32_32x32x16_bf16 v[192:207], v[12:15], v[100:103], v[192:207]
    ds_read_b128 v[56:59], v243 offset:16384
    ds_read_b64_tr_b16 v[124:125], v244 offset:30720
    ds_read_b64_tr_b16 v[126:127], v244 offset:31232
    s_waitcnt lgkmcnt(14)
    v_mfma_f32_32x32x16_bf16 v[176:191], v[16:19], v[104:107], v[176:191]
    ds_read_b128 v[36:39], v240 offset:20480
    v_mfma_f32_32x32x16_bf16 v[192:207], v[20:23], v[104:107], v[192:207]
    ds_read_b128 v[44:47], v241 offset:20480
    s_waitcnt lgkmcnt(14)
    v_mfma_f32_32x32x16_bf16 v[176:191], v[24:27], v[108:111], v[176:191]
    ds_read_b128 v[52:55], v242 offset:20480
    v_mfma_f32_32x32x16_bf16 v[192:207], v[28:31], v[108:111], v[192:207]
    ds_read_b128 v[60:63], v243 offset:20480
    s_waitcnt lgkmcnt(13)
    v_mfma_f32_32x32x16_bf16 v[144:159], v[112:115], v[32:35], v[144:159]
    ds_read_b64_tr_b16 v[96:97], v244 offset:32768
    ds_read_b64_tr_b16 v[98:99], v244 offset:33280
    s_waitcnt lgkmcnt(12)
    v_mfma_f32_32x32x16_bf16 v[144:159], v[116:119], v[40:43], v[144:159]
    ds_read_b64_tr_b16 v[100:101], v244 offset:34816
    ds_read_b64_tr_b16 v[102:103], v244 offset:35328
    s_waitcnt lgkmcnt(11)
    v_mfma_f32_32x32x16_bf16 v[144:159], v[120:123], v[48:51], v[144:159]
    ds_read_b64_tr_b16 v[104:105], v244 offset:36864
    ds_read_b64_tr_b16 v[106:107], v244 offset:37376
    s_waitcnt lgkmcnt(10)
    v_mfma_f32_32x32x16_bf16 v[144:159], v[124:127], v[56:59], v[144:159]
    ds_read_b64_tr_b16 v[108:109], v244 offset:38912
    ds_read_b64_tr_b16 v[110:111], v244 offset:39424
    s_waitcnt lgkmcnt(11)
    v_mfma_f32_32x32x16_bf16 v[160:175], v[112:115], v[36:39], v[160:175]
    s_waitcnt lgkmcnt(10)
    v_mfma_f32_32x32x16_bf16 v[160:175], v[116:119], v[44:47], v[160:175]
    v_pk_mul_f32 v[144:145], v[144:145], s[90:91]
    v_pk_mul_f32 v[146:147], v[146:147], s[90:91]
    v_pk_mul_f32 v[148:149], v[148:149], s[90:91]
    v_pk_mul_f32 v[150:151], v[150:151], s[90:91]
    s_waitcnt lgkmcnt(9)
    v_mfma_f32_32x32x16_bf16 v[160:175], v[120:123], v[52:55], v[160:175]
    v_cvt_pk_bf16_f32 v144, v144, v145
    v_cvt_pk_bf16_f32 v145, v146, v147
    v_cvt_pk_bf16_f32 v146, v148, v149
    v_cvt_pk_bf16_f32 v147, v150, v151
    s_waitcnt lgkmcnt(8)
    v_mfma_f32_32x32x16_bf16 v[160:175], v[124:127], v[60:63], v[160:175]
    buffer_store_dwordx4 v[144:147], v246, s[44:47], s70 offen
    v_pk_mul_f32 v[152:153], v[152:153], s[90:91]
    v_pk_mul_f32 v[154:155], v[154:155], s[90:91]
    v_pk_mul_f32 v[156:157], v[156:157], s[90:91]
    s_waitcnt lgkmcnt(6)
    v_mfma_f32_32x32x16_bf16 v[176:191], v[32:35], v[96:99], v[176:191]
    v_pk_mul_f32 v[158:159], v[158:159], s[90:91]
    v_cvt_pk_bf16_f32 v152, v152, v153
    v_cvt_pk_bf16_f32 v153, v154, v155
    v_cvt_pk_bf16_f32 v154, v156, v157
    s_barrier
    ds_read_b64_tr_b16 v[112:113], v244 offset:40960
    ds_read_b64_tr_b16 v[114:115], v244 offset:41472
    s_waitcnt lgkmcnt(6)
    v_mfma_f32_32x32x16_bf16 v[176:191], v[40:43], v[100:103], v[176:191]
    v_cvt_pk_bf16_f32 v155, v158, v159
    buffer_store_dwordx4 v[152:155], v246, s[44:47], s71 offen
    v_pk_mul_f32 v[160:161], v[160:161], s[90:91]
    v_pk_mul_f32 v[162:163], v[162:163], s[90:91]
    ds_read_b64_tr_b16 v[116:117], v244 offset:43008
    ds_read_b64_tr_b16 v[118:119], v244 offset:43520
    s_waitcnt lgkmcnt(6)
    v_mfma_f32_32x32x16_bf16 v[176:191], v[48:51], v[104:107], v[176:191]
    v_pk_mul_f32 v[164:165], v[164:165], s[90:91]
    v_pk_mul_f32 v[166:167], v[166:167], s[90:91]
    v_cvt_pk_bf16_f32 v160, v160, v161
    v_cvt_pk_bf16_f32 v161, v162, v163
    ds_read_b64_tr_b16 v[120:121], v244 offset:45056
    ds_read_b64_tr_b16 v[122:123], v244 offset:45568
    s_waitcnt lgkmcnt(6)
    v_mfma_f32_32x32x16_bf16 v[176:191], v[56:59], v[108:111], v[176:191]
    v_cvt_pk_bf16_f32 v162, v164, v165
    v_cvt_pk_bf16_f32 v163, v166, v167
    buffer_store_dwordx4 v[160:163], v246, s[44:47], s72 offen
    v_pk_mul_f32 v[168:169], v[168:169], s[90:91]
    ds_read_b64_tr_b16 v[124:125], v244 offset:47104
    ds_read_b64_tr_b16 v[126:127], v244 offset:47616
    v_mfma_f32_32x32x16_bf16 v[192:207], v[36:39], v[96:99], v[192:207]
    v_pk_mul_f32 v[170:171], v[170:171], s[90:91]
    v_pk_mul_f32 v[172:173], v[172:173], s[90:91]
    v_pk_mul_f32 v[174:175], v[174:175], s[90:91]
    v_cvt_pk_bf16_f32 v168, v168, v169
    v_mfma_f32_32x32x16_bf16 v[192:207], v[44:47], v[100:103], v[192:207]
    v_cvt_pk_bf16_f32 v169, v170, v171
    v_cvt_pk_bf16_f32 v170, v172, v173
    v_cvt_pk_bf16_f32 v171, v174, v175
    buffer_store_dwordx4 v[168:171], v246, s[44:47], s73 offen
    ds_read_b64_tr_b16 v[96:97], v244 offset:49152
    ds_read_b64_tr_b16 v[98:99], v244 offset:49664
    v_mfma_f32_32x32x16_bf16 v[192:207], v[52:55], v[104:107], v[192:207]
    v_cvt_pk_bf16_f32 v176, v176, v177
    v_cvt_pk_bf16_f32 v177, v178, v179
    v_cvt_pk_bf16_f32 v178, v180, v181
    v_cvt_pk_bf16_f32 v179, v182, v183
    ds_read_b64_tr_b16 v[100:101], v244 offset:51200
    ds_read_b64_tr_b16 v[102:103], v244 offset:51712
    v_mfma_f32_32x32x16_bf16 v[192:207], v[60:63], v[108:111], v[192:207]
    v_cvt_pk_bf16_f32 v180, v184, v185
    v_cvt_pk_bf16_f32 v181, v186, v187
    v_cvt_pk_bf16_f32 v182, v188, v189
    v_cvt_pk_bf16_f32 v183, v190, v191
    ds_read_b64_tr_b16 v[104:105], v244 offset:53248
    ds_read_b64_tr_b16 v[106:107], v244 offset:53760
    s_waitcnt lgkmcnt(12)
    v_mfma_f32_32x32x16_bf16 v[208:223], v[112:115], v[64:67], v[208:223]
    s_cmp_eq_u32 s55, 0
    s_cbranch_scc1 fz_kernel_sv0
    buffer_store_dwordx4 v[176:179], v248, s[44:47], s70 offen offset:1024
    buffer_store_dwordx4 v[180:183], v248, s[44:47], s70 offen offset:1536
fz_kernel_sv0:
    ds_read_b64_tr_b16 v[108:109], v244 offset:55296
    ds_read_b64_tr_b16 v[110:111], v244 offset:55808
    s_waitcnt lgkmcnt(12)
    v_mfma_f32_32x32x16_bf16 v[208:223], v[116:119], v[72:75], v[208:223]
    v_cvt_pk_bf16_f32 v192, v192, v193
    v_cvt_pk_bf16_f32 v193, v194, v195
    v_cvt_pk_bf16_f32 v194, v196, v197
    v_cvt_pk_bf16_f32 v195, v198, v199
    ds_read_b64_tr_b16 v[112:113], v244 offset:57344
    ds_read_b64_tr_b16 v[114:115], v244 offset:57856
    s_waitcnt lgkmcnt(12)
    v_mfma_f32_32x32x16_bf16 v[208:223], v[120:123], v[80:83], v[208:223]
    v_cvt_pk_bf16_f32 v196, v200, v201
    v_cvt_pk_bf16_f32 v197, v202, v203
    v_cvt_pk_bf16_f32 v198, v204, v205
    v_cvt_pk_bf16_f32 v199, v206, v207
    ds_read_b64_tr_b16 v[116:117], v244 offset:59392
    ds_read_b64_tr_b16 v[118:119], v244 offset:59904
    s_waitcnt lgkmcnt(12)
    v_mfma_f32_32x32x16_bf16 v[208:223], v[124:127], v[88:91], v[208:223]
    s_cmp_eq_u32 s55, 0
    s_cbranch_scc1 fz_kernel_sv1
    buffer_store_dwordx4 v[192:195], v248, s[44:47], s72 offen offset:1024
    buffer_store_dwordx4 v[196:199], v248, s[44:47], s72 offen offset:1536
fz_kernel_sv1:
    ds_write_b128 v252, v[176:179] offset:8192
    ds_write_b128 v252, v[180:183] offset:9216
    ds_read_b64_tr_b16 v[120:121], v244 offset:61440
    ds_read_b64_tr_b16 v[122:123], v244 offset:61952
    s_waitcnt lgkmcnt(14)
    v_mfma_f32_32x32x16_bf16 v[208:223], v[96:99], v[0:3], v[208:223]
    ds_read_b64_tr_b16 v[124:125], v244 offset:63488
    ds_read_b64_tr_b16 v[126:127], v244 offset:64000
    s_waitcnt lgkmcnt(14)
    v_mfma_f32_32x32x16_bf16 v[208:223], v[100:103], v[8:11], v[208:223]
    v_lshrrev_b32 v148, 5, v250
    v_and_b32 v149, 31, v250
    v_min_u32 v241, 16, v149
    v_mad_u32_u24 v241, v148, 17, v241
    ds_read_b64_tr_b16 v[96:97], v244 offset:40960
    ds_read_b64_tr_b16 v[98:99], v244 offset:41472
    s_waitcnt lgkmcnt(14)
    v_mfma_f32_32x32x16_bf16 v[208:223], v[104:107], v[16:19], v[208:223]
    v_lshlrev_b32 v241, 4, v241
    v_add_u32 v65, 31744, v251
    v_add_u32 v66, 97792, v251
    v_mov_b32 v64, 0xdddddddd
    ds_read_b64_tr_b16 v[100:101], v244 offset:43008
    ds_read_b64_tr_b16 v[102:103], v244 offset:43520
    s_waitcnt lgkmcnt(14)
    v_mfma_f32_32x32x16_bf16 v[208:223], v[108:111], v[24:27], v[208:223]
    v_and_b32 v150, 0xffff, v248
    v_add_u32 v67, 32768, v150
    v_mov_b32 v0, 0x3f803f80
    v_lshl_add_u32 v149, v148, 4, s94
    ds_read_b64_tr_b16 v[104:105], v244 offset:45056
    ds_read_b64_tr_b16 v[106:107], v244 offset:45568
    s_waitcnt lgkmcnt(14)
    v_mfma_f32_32x32x16_bf16 v[208:223], v[112:115], v[32:35], v[208:223]
    v_add_u32 v151, s95, v150
    v_cndmask_b32_e64 v1, v149, v151, s[26:27]
    v_add_u32 v151, 8224, v151
    v_cndmask_b32_e64 v2, v151, v149, s[26:27]
    ds_read_b64_tr_b16 v[108:109], v244 offset:47104
    ds_read_b64_tr_b16 v[110:111], v244 offset:47616
    s_waitcnt lgkmcnt(14)
    v_mfma_f32_32x32x16_bf16 v[208:223], v[116:119], v[40:43], v[208:223]
    v_lshl_add_u32 v149, v148, 4, s96
    v_add_u32 v151, s97, v150
    v_cndmask_b32_e64 v242, v149, v151, s[26:27]
    v_mov_b32 v3, 0
    ds_read_b64_tr_b16 v[112:113], v244 offset:49152
    ds_read_b64_tr_b16 v[114:115], v244 offset:49664
    s_waitcnt lgkmcnt(12)
    v_mfma_f32_32x32x16_bf16 v[208:223], v[120:123], v[48:51], v[208:223]
    v_mov_b32 v8, 0
    v_mov_b32 v9, 0
    v_mov_b32 v10, 0
    v_mov_b32 v11, 0
    ds_read_b64_tr_b16 v[116:117], v244 offset:51200
    ds_read_b64_tr_b16 v[118:119], v244 offset:51712
    s_waitcnt lgkmcnt(12)
    v_mfma_f32_32x32x16_bf16 v[208:223], v[124:127], v[56:59], v[208:223]
    ds_read_b64_tr_b16 v[120:121], v244 offset:53248
    ds_read_b64_tr_b16 v[122:123], v244 offset:53760
    s_waitcnt lgkmcnt(12)
    v_mfma_f32_32x32x16_bf16 v[224:239], v[96:99], v[68:71], v[224:239]
    s_cmp_lg_u32 s55, 0
    s_cbranch_scc1 fz_kernel_pb0
    v_lshlrev_b32 v246, 2, v250
    s_mov_b32 exec_hi, 0
    s_waitcnt vmcnt(0)
    v_cmp_ne_u32 vcc, v254, v247
    s_cbranch_vccnz fz_kernel_far0
fz_kernel_near0:
    buffer_store_dword v249, v246, s[44:47], s76 offen
fz_kernel_fb0:
    s_mov_b32 exec_hi, -1
fz_kernel_pb0:
    ds_read_b64_tr_b16 v[124:125], v244 offset:55296
    ds_read_b64_tr_b16 v[126:127], v244 offset:55808
    s_waitcnt lgkmcnt(12)
    v_mfma_f32_32x32x16_bf16 v[224:239], v[100:103], v[76:79], v[224:239]
    v_pk_mul_f32 v[208:209], v[208:209], s[68:69]
    v_pk_mul_f32 v[210:211], v[210:211], s[68:69]
    v_pk_mul_f32 v[212:213], v[212:213], s[68:69]
    v_pk_mul_f32 v[214:215], v[214:215], s[68:69]
    v_pk_mul_f32 v[216:217], v[216:217], s[68:69]
    v_pk_mul_f32 v[218:219], v[218:219], s[68:69]
    v_pk_mul_f32 v[220:221], v[220:221], s[68:69]
    v_pk_mul_f32 v[222:223], v[222:223], s[68:69]
    v_cvt_pk_bf16_f32 v208, v208, v209
    v_cvt_pk_bf16_f32 v209, v210, v211
    v_cvt_pk_bf16_f32 v210, v212, v213
    v_cvt_pk_bf16_f32 v211, v214, v215
    v_cvt_pk_bf16_f32 v212, v216, v217
    v_cvt_pk_bf16_f32 v213, v218, v219
    v_cvt_pk_bf16_f32 v214, v220, v221
    v_cvt_pk_bf16_f32 v215, v222, v223
    ds_write_b128 v252, v[208:211] offset:0
    ds_write_b128 v252, v[212:215] offset:1024
    ds_read_b64_tr_b16 v[96:97], v244 offset:57344
    ds_read_b64_tr_b16 v[98:99], v244 offset:57856
    s_waitcnt lgkmcnt(14)
    v_mfma_f32_32x32x16_bf16 v[224:239], v[104:107], v[84:87], v[224:239]
    ds_read_b64_tr_b16 v[100:101], v244 offset:59392
    ds_read_b64_tr_b16 v[102:103], v244 offset:59904
    s_waitcnt lgkmcnt(14)
    v_mfma_f32_32x32x16_bf16 v[224:239], v[108:111], v[92:95], v[224:239]
    s_cmp_lg_u32 s55, 1
    s_cbranch_scc1 fz_kernel_pb1
    v_lshlrev_b32 v246, 2, v250
    s_mov_b32 exec_hi, 0
    s_waitcnt vmcnt(0)
    v_cmp_ne_u32 vcc, v254, v247
    s_cbranch_vccnz fz_kernel_far1
fz_kernel_near1:
    buffer_store_dword v249, v246, s[44:47], s76 offen
fz_kernel_fb1:
    s_mov_b32 exec_hi, -1
fz_kernel_pb1:
    s_waitcnt lgkmcnt(4)
    s_barrier
    ds_read_b64_tr_b16 v[104:105], v244 offset:61440
    ds_read_b64_tr_b16 v[106:107], v244 offset:61952
    v_mfma_f32_32x32x16_bf16 v[224:239], v[112:115], v[4:7], v[224:239]
    ds_read_b64_tr_b16 v[108:109], v244 offset:63488
    ds_read_b64_tr_b16 v[110:111], v244 offset:64000
    v_mfma_f32_32x32x16_bf16 v[224:239], v[116:119], v[12:15], v[224:239]
    v_mfma_f32_32x32x16_bf16 v[224:239], v[120:123], v[20:23], v[224:239]
    v_mov_b32 v4, 0
    v_mov_b32 v5, 0
    v_mov_b32 v6, 0
    v_mov_b32 v7, 0
    v_mfma_f32_32x32x16_bf16 v[224:239], v[124:127], v[28:31], v[224:239]
    v_mov_b32 v12, 0
    v_mov_b32 v13, 0
    v_mov_b32 v14, 0
    v_mov_b32 v15, 0
    s_waitcnt lgkmcnt(6)
    v_mfma_f32_32x32x16_bf16 v[224:239], v[96:99], v[36:39], v[224:239]
    s_waitcnt lgkmcnt(4)
    v_mfma_f32_32x32x16_bf16 v[224:239], v[100:103], v[44:47], v[224:239]
    s_waitcnt lgkmcnt(2)
    v_mfma_f32_32x32x16_bf16 v[224:239], v[104:107], v[52:55], v[224:239]
    s_mov_b32 vcc_lo, 0x110000
    s_mov_b32 vcc_hi, 0x110000
    s_waitcnt lgkmcnt(0)
    v_mfma_f32_32x32x16_bf16 v[224:239], v[108:111], v[60:63], v[224:239]
    v_bfe_u32 v247, v250, 3, 2
    v_and_b32 v148, 7, v250
    v_lshl_add_u32 v247, v247, 11, v148
    v_lshlrev_b32 v247, 3, v247
    v_cndmask_b32 v56, 0, v0, vcc
    v_cndmask_b32 v57, 0, v0, vcc
    v_cndmask_b32 v58, 0, v0, vcc
    v_cndmask_b32 v59, 0, v0, vcc
    v_cndmask_b32 v60, 0, v0, vcc
    v_cndmask_b32 v61, 0, v0, vcc
    v_cndmask_b32 v62, 0, v0, vcc
    v_cndmask_b32 v63, 0, v0, vcc
    v_pk_mul_f32 v[224:225], v[224:225], s[68:69]
    v_pk_mul_f32 v[226:227], v[226:227], s[68:69]
    v_pk_mul_f32 v[228:229], v[228:229], s[68:69]
    v_pk_mul_f32 v[230:231], v[230:231], s[68:69]
    v_pk_mul_f32 v[232:233], v[232:233], s[68:69]
    v_pk_mul_f32 v[234:235], v[234:235], s[68:69]
    v_pk_mul_f32 v[236:237], v[236:237], s[68:69]
    v_pk_mul_f32 v[238:239], v[238:239], s[68:69]
    v_cvt_pk_bf16_f32 v224, v224, v225
    v_cvt_pk_bf16_f32 v225, v226, v227
    v_cvt_pk_bf16_f32 v226, v228, v229
    v_cvt_pk_bf16_f32 v227, v230, v231
    v_cvt_pk_bf16_f32 v228, v232, v233
    v_cvt_pk_bf16_f32 v229, v234, v235
    v_cvt_pk_bf16_f32 v230, v236, v237
    v_cvt_pk_bf16_f32 v231, v238, v239
    s_nop 1
fz_kernel_maps:
    v_mfma_f32_32x32x16_bf16 v[16:31], v[136:139], v[224:227], 0
    v_mfma_f32_32x32x16_bf16 v[32:47], v[140:143], v[228:231], 0
    s_cmp_lg_u32 s55, 0
    v_cndmask_b32_e64 v176, v0, v192, s[26:27]
    v_cndmask_b32_e64 v177, v0, v193, s[26:27]
    v_cndmask_b32_e64 v178, v0, v194, s[26:27]
    v_cndmask_b32_e64 v179, v0, v195, s[26:27]
    v_cndmask_b32_e64 v180, v0, v196, s[26:27]
    v_cndmask_b32_e64 v181, v0, v197, s[26:27]
    v_cndmask_b32_e64 v182, v0, v198, s[26:27]
    v_cndmask_b32_e64 v183, v0, v199, s[26:27]
    v_cndmask_b32_e64 v184, v192, v0, s[26:27]
    v_cndmask_b32_e64 v185, v193, v0, s[26:27]
    s_mov_b32 s64, 0x71800000
    v_exp_f32 v144, v16
    v_exp_f32 v145, v17
    v_exp_f32 v146, v18
    v_exp_f32 v147, v19
    v_exp_f32 v148, v20
    v_pk_add_f32 v[76:77], v[144:145], v[146:147]
    v_exp_f32 v149, v21
    v_exp_f32 v150, v22
    v_exp_f32 v151, v23
    v_exp_f32_e64 v152, -v16
    v_pk_add_f32 v[78:79], v[148:149], v[150:151]
    v_exp_f32_e64 v153, -v17
    v_pk_add_f32 v[76:77], v[76:77], v[78:79]
    v_exp_f32_e64 v154, -v18
    v_exp_f32_e64 v155, -v19
    v_exp_f32_e64 v156, -v20
    v_pk_add_f32 v[78:79], v[152:153], v[154:155]
    v_add_f32 v72, v76, v77
    v_exp_f32_e64 v157, -v21
    v_exp_f32_e64 v158, -v22
    v_pk_add_f32 v[78:79], v[78:79], v[156:157]
    v_exp_f32_e64 v159, -v23
    v_exp_f32 v160, v32
    v_pk_add_f32 v[78:79], v[78:79], v[158:159]
    v_exp_f32 v161, v33
    v_add_f32 v73, v78, v79
    v_exp_f32 v162, v34
    v_exp_f32 v163, v35
    v_permlane32_swap_b32 v72, v73
    v_exp_f32 v164, v36
    v_add_f32 v72, v72, v73
    v_cmp_nge_f32_e64 s[90:91], s64, v72
    v_rcp_f32 v72, v72
    v_pk_add_f32 v[76:77], v[160:161], v[162:163]
    v_exp_f32 v165, v37
    v_mov_b32 v73, v72
    v_exp_f32 v166, v38
    v_exp_f32 v167, v39
    v_permlane32_swap_b32 v72, v73
    v_exp_f32_e64 v168, -v32
    v_pk_add_f32 v[78:79], v[164:165], v[166:167]
    v_exp_f32_e64 v169, -v33
    v_pk_add_f32 v[76:77], v[76:77], v[78:79]
    v_exp_f32_e64 v170, -v34
    v_exp_f32_e64 v171, -v35
    v_exp_f32_e64 v172, -v36
    v_pk_add_f32 v[78:79], v[168:169], v[170:171]
    v_add_f32 v74, v76, v77
    v_exp_f32_e64 v173, -v37
    v_exp_f32_e64 v174, -v38
    v_pk_add_f32 v[78:79], v[78:79], v[172:173]
    v_exp_f32_e64 v175, -v39
    v_pk_mul_f32 v[144:145], v[144:145], v[72:73] op_sel_hi:[1,0]
    v_pk_add_f32 v[78:79], v[78:79], v[174:175]
    v_add_f32 v75, v78, v79
    v_pk_mul_f32 v[146:147], v[146:147], v[72:73] op_sel_hi:[1,0]
    v_pk_mul_f32 v[148:149], v[148:149], v[72:73] op_sel_hi:[1,0]
    v_permlane32_swap_b32 v74, v75
    v_pk_mul_f32 v[150:151], v[150:151], v[72:73] op_sel_hi:[1,0]
    v_add_f32 v74, v74, v75
    v_cmp_nge_f32_e64 vcc, s64, v74
    v_rcp_f32 v74, v74
    v_pk_mul_f32 v[152:153], v[152:153], v[72:73] op_sel:[0,1]
    v_mov_b32 v75, v74
    v_pk_mul_f32 v[154:155], v[154:155], v[72:73] op_sel:[0,1]
    v_pk_mul_f32 v[156:157], v[156:157], v[72:73] op_sel:[0,1]
    v_permlane32_swap_b32 v74, v75
    v_pk_mul_f32 v[158:159], v[158:159], v[72:73] op_sel:[0,1]
    s_or_b64 vcc, vcc, s[90:91]
    s_cmp_lg_u32 s55, 0
    v_pk_mul_f32 v[160:161], v[160:161], v[74:75] op_sel_hi:[1,0]
    v_pk_mul_f32 v[162:163], v[162:163], v[74:75] op_sel_hi:[1,0]
    v_pk_mul_f32 v[164:165], v[164:165], v[74:75] op_sel_hi:[1,0]
    v_pk_mul_f32 v[166:167], v[166:167], v[74:75] op_sel_hi:[1,0]
    v_pk_mul_f32 v[168:169], v[168:169], v[74:75] op_sel:[0,1]
    v_pk_mul_f32 v[170:171], v[170:171], v[74:75] op_sel:[0,1]
    v_pk_mul_f32 v[172:173], v[172:173], v[74:75] op_sel:[0,1]
    v_pk_mul_f32 v[174:175], v[174:175], v[74:75] op_sel:[0,1]
    s_cbranch_vccnz fz_kernel_sm
    v_cvt_pk_bf16_f32 v80, v144, v145
    v_cvt_pk_bf16_f32 v81, v146, v147
    v_cvt_pk_bf16_f32 v82, v148, v149
    v_cvt_pk_bf16_f32 v83, v150, v151
    v_cvt_pk_bf16_f32 v84, v152, v153
    v_cvt_pk_bf16_f32 v85, v154, v155
    v_cvt_pk_bf16_f32 v86, v156, v157
    v_cvt_pk_bf16_f32 v87, v158, v159
    v_cvt_pk_bf16_f32 v88, v160, v161
    v_cvt_pk_bf16_f32 v89, v162, v163
    v_mfma_f32_32x32x16_bf16 v[96:111], v[80:83], v[128:131], 0
    v_mfma_f32_32x32x16_bf16 v[96:111], v[84:87], v[132:135], v[96:111]
    v_cvt_pk_bf16_f32 v90, v164, v165
    v_cvt_pk_bf16_f32 v91, v166, v167
    v_cvt_pk_bf16_f32 v92, v168, v169
    v_cvt_pk_bf16_f32 v93, v170, v171
    v_cvt_pk_bf16_f32 v94, v172, v173
    v_cvt_pk_bf16_f32 v95, v174, v175
fz_kernel_smr0:
    s_cbranch_scc1 fz_kernel_x2
    v_cndmask_b32_e64 v186, v194, v0, s[26:27]
    v_mfma_f32_32x32x16_bf16 v[112:127], v[88:91], v[128:131], 0
    v_mfma_f32_32x32x16_bf16 v[112:127], v[92:95], v[132:135], v[112:127]
    v_cndmask_b32_e64 v187, v195, v0, s[26:27]
    v_cndmask_b32_e64 v188, v196, v0, s[26:27]
    v_cvt_pk_bf16_f32 v96, v96, v97
    v_cvt_pk_bf16_f32 v97, v98, v99
    v_cvt_pk_bf16_f32 v98, v100, v101
    v_cvt_pk_bf16_f32 v99, v102, v103
    v_cvt_pk_bf16_f32 v100, v104, v105
    v_cvt_pk_bf16_f32 v101, v106, v107
    v_mfma_f32_32x32x16_bf16 v[16:31], v[96:99], v[176:179], 0
    v_cvt_pk_bf16_f32 v102, v108, v109
    v_cvt_pk_bf16_f32 v103, v110, v111
    v_cndmask_b32_e64 v189, v197, v0, s[26:27]
    v_cndmask_b32_e64 v190, v198, v0, s[26:27]
    v_mfma_f32_32x32x16_bf16 v[16:31], v[100:103], v[180:183], v[16:31]
    v_cndmask_b32_e64 v191, v199, v0, s[26:27]
    v_cvt_pk_bf16_f32 v112, v112, v113
    v_cvt_pk_bf16_f32 v113, v114, v115
    v_cvt_pk_bf16_f32 v114, v116, v117
    v_cvt_pk_bf16_f32 v115, v118, v119
    v_cvt_pk_bf16_f32 v116, v120, v121
    v_cvt_pk_bf16_f32 v117, v122, v123
    v_mfma_f32_32x32x16_bf16 v[32:47], v[112:115], v[184:187], 0
    v_cvt_pk_bf16_f32 v118, v124, v125
    v_cvt_pk_bf16_f32 v119, v126, v127
    s_nop 1
    v_mfma_f32_32x32x16_bf16 v[32:47], v[116:119], v[188:191], v[32:47]
    s_mov_b32 exec_lo, 0x1ffff
    s_mov_b32 exec_hi, 0x1ffff
    ds_write_b128 v1, v[16:19] offset:16384
    ds_write_b128 v1, v[20:23] offset:18448
    ds_write_b128 v1, v[24:27] offset:20512
    ds_write_b128 v1, v[28:31] offset:22576
    s_nop 3
    s_mov_b32 exec_lo, 0xffff0001
    s_mov_b32 exec_hi, 0xffff0001
    ds_write_b128 v2, v[32:35] offset:16416
    ds_write_b128 v2, v[36:39] offset:18480
    ds_write_b128 v2, v[40:43] offset:20544
    ds_write_b128 v2, v[44:47] offset:22608
    s_mov_b64 exec, -1
fz_kernel_x2:
    s_waitcnt vmcnt(0) lgkmcnt(0)
    s_barrier
    ds_read_b128 v[48:51], v252 offset:8192
    ds_read_b128 v[52:55], v65 offset:33024
    s_mov_b64 exec, s[26:27]
    ds_read_b128 v[56:59], v67 offset:33024
    s_mov_b64 exec, -1
    s_bitcmp1_b32 s63, 0
    s_cbranch_scc0 fz_kernel_r1
    ds_read_b128 v[96:99], v242 offset:16384
    ds_read_b128 v[100:103], v242 offset:16896
    ds_read_b128 v[104:107], v242 offset:17408
    ds_read_b128 v[108:111], v242 offset:17920
    ds_read_b128 v[112:115], v242 offset:18448
    ds_read_b128 v[116:119], v242 offset:18960
    ds_read_b128 v[120:123], v242 offset:19472
    ds_read_b128 v[124:127], v242 offset:19984
fz_kernel_r1:
    v_mov_b32 v0, 0
    v_mov_b32 v1, 0
    v_mov_b32 v2, 0
    v_add_u32 v68, 66048, v67
    s_mov_b32 s96, 0
    s_mov_b32 s93, 0
    s_mov_b32 s92, 0
    s_lshr_b32 s78, s3, 2
    s_mul_i32 s74, s3, 4128
    s_lshr_b32 s76, s3, 1
    s_and_b32 s77, s3, 1
    s_bfe_u32 s75, s2, 0x20003
    s_and_b32 s64, s3, 3
    s_lshl2_add_u32 s70, s61, s64
    s_lshl_b32 s70, s70, 15
    s_mul_i32 s64, s78, 12288
    s_add_u32 s70, s70, s64
    s_add_u32 s70, s70, 0x202000
    s_and_b32 s64, s58, 3
    s_lshl1_add_u32 s64, s64, s77
    s_cmp_eq_u32 s55, 0
    s_cselect_b32 s64, s3, s64
    s_lshl_b32 s79, s64, 6
    s_add_u32 s79, s79, s57
    s_add_u32 s79, s79, 0x1100200
    s_waitcnt lgkmcnt(1)
    v_mfma_f32_32x32x16_bf16 v[16:31], v[52:55], v[48:51], 0
    ds_read_b128 v[52:55], v65 offset:35088
    s_lshl_b32 s71, s75, 1
    s_add_u32 s71, s71, s77
    s_lshl_b32 s71, s71, 17
    s_lshl_b32 s64, s76, 13
    s_add_u32 s71, s71, s64
    s_add_u32 s71, s71, 0x1400000
    s_and_b32 s72, s2, 7
    s_lshl_b32 s65, s62, 3
    s_add_u32 s72, s72, s65
    s_lshl_b32 s72, s72, 16
    s_add_u32 s72, s72, s64
    s_add_u32 s72, s72, 0xd00000
    s_setprio 3
    v_exp_f32 v16, v16
    v_exp_f32 v17, v17
    s_mov_b64 exec, s[26:27]
    ds_read_b128 v[60:63], v67 offset:33536
    s_mov_b64 exec, -1
    v_exp_f32 v18, v18
    v_exp_f32 v19, v19
    s_bitcmp1_b32 s63, 0
    s_cbranch_scc0 fz_kernel_r2
    s_lshl_b32 s64, s54, 2
    s_add_u32 s64, s64, s76
    s_lshl_b32 s64, s64, 4
    s_add_u32 s64, s64, s52
    s_lshl_b32 s64, s64, 1
    s_add_u32 s64, s64, s77
    s_mul_i32 s64, s64, 1088
    s_add_u32 s64, s64, 0xa00000
    s_waitcnt lgkmcnt(2)
    v_pk_add_f32 v[96:97], v[96:97], v[104:105]
    v_pk_add_f32 v[98:99], v[98:99], v[106:107]
    v_pk_add_f32 v[100:101], v[100:101], v[108:109]
    v_pk_add_f32 v[102:103], v[102:103], v[110:111]
    v_pk_add_f32 v[112:113], v[112:113], v[120:121]
    v_pk_add_f32 v[114:115], v[114:115], v[122:123]
    v_pk_add_f32 v[116:117], v[116:117], v[124:125]
    v_pk_add_f32 v[118:119], v[118:119], v[126:127]
    v_pk_add_f32 v[96:97], v[96:97], v[100:101]
    v_pk_add_f32 v[98:99], v[98:99], v[102:103]
    v_pk_add_f32 v[112:113], v[112:113], v[116:117]
    v_pk_add_f32 v[114:115], v[114:115], v[118:119]
    s_mov_b32 exec_lo, 0x1ffff
    s_mov_b32 exec_hi, 0x1ffff
    buffer_store_dwordx4 v[96:99], v241, s[44:47], s64 offen offset:0 sc1
    buffer_store_dwordx4 v[112:115], v241, s[44:47], s64 offen offset:544 sc1
    s_mov_b64 exec, -1
fz_kernel_r2:
    v_exp_f32 v20, v20
    v_exp_f32 v21, v21
    s_waitcnt lgkmcnt(1)
    v_exp_f32 v22, v22
    v_mfma_f32_32x32x16_bf16 v[32:47], v[52:55], v[48:51], 0
    ds_read_b128 v[52:55], v65 offset:37152
    v_exp_f32 v23, v23
    v_exp_f32 v24, v24
    s_lshl1_add_u32 m0, s74, 97792
    s_add_u32 s64, s70, 0
    buffer_load_dwordx4 v251, s[44:47], s64 offen lds
    buffer_load_dwordx4 v251, s[44:47], s64 offen offset:1024 lds
    v_exp_f32 v25, v25
    v_exp_f32 v26, v26
    s_waitcnt lgkmcnt(3)
    v_exp_f32 v27, v27
    v_smfmac_f32_32x32x32_bf16 v[0:15], v[56:59], v[16:23], v64
    s_mov_b64 exec, s[26:27]
    ds_read_b128 v[56:59], v67 offset:35088
    s_mov_b64 exec, -1
    v_exp_f32 v28, v28
    v_exp_f32 v29, v29
    s_bitcmp1_b32 s63, 3
    s_cbranch_scc0 fz_kernel_r3
    s_cmp_eq_u32 s55, 0
    s_cselect_b64 s[48:49], s[8:9], s[16:17]
    s_mov_b32 s50, 0x80000
    s_mov_b32 s51, 0x00020000
    v_lshrrev_b32 v132, 3, v250
    v_lshrrev_b32 v133, 2, v250
    v_and_b32 v133, 4, v133
    v_and_b32 v134, 7, v250
    v_xor_b32 v133, v133, v134
    v_lshlrev_b32 v132, 10, v132
    v_lshl_add_u32 v132, v133, 4, v132
    s_lshl_b32 s64, s52, 15
    s_lshl_b32 s65, s54, 7
    s_lshl_b32 m0, s55, 12
    s_add_u32 s64, s64, s65
    buffer_load_dwordx4 v132, s[48:51], s64 offen offset:0 lds
    s_add_u32 s64, s64, 7168
    buffer_load_dwordx4 v132, s[48:51], s64 offen offset:1024 lds
    s_add_u32 s64, s64, 7168
    buffer_load_dwordx4 v132, s[48:51], s64 offen offset:2048 lds
    s_add_u32 s64, s64, 7168
    buffer_load_dwordx4 v132, s[48:51], s64 offen offset:3072 lds
fz_kernel_r3:
    v_exp_f32 v30, v30
    v_exp_f32 v31, v31
    v_exp_f32 v32, v32
    s_waitcnt lgkmcnt(2)
    v_exp_f32 v33, v33
    v_smfmac_f32_32x32x32_bf16 v[0:15], v[60:63], v[24:31], v64
    s_mov_b64 exec, s[26:27]
    ds_read_b128 v[60:63], v67 offset:35600
    s_mov_b64 exec, -1
    v_exp_f32 v34, v34
    v_exp_f32 v35, v35
    v_exp_f32 v36, v36
    v_exp_f32 v37, v37
    s_waitcnt lgkmcnt(2)
    v_exp_f32 v38, v38
    v_mfma_f32_32x32x16_bf16 v[16:31], v[52:55], v[48:51], 0
    ds_read_b128 v[52:55], v65 offset:39216
    v_exp_f32 v39, v39
    v_exp_f32 v40, v40
    s_lshl1_add_u32 m0, s74, 99856
    s_add_u32 s64, s70, 2048
    buffer_load_dwordx4 v251, s[44:47], s64 offen lds
    buffer_load_dwordx4 v251, s[44:47], s64 offen offset:1024 lds
    v_exp_f32 v41, v41
    v_exp_f32 v42, v42
    s_waitcnt lgkmcnt(2)
    v_exp_f32 v43, v43
    v_smfmac_f32_32x32x32_bf16 v[0:15], v[56:59], v[32:39], v64
    s_mov_b64 exec, s[26:27]
    ds_read_b128 v[56:59], v67 offset:37152
    s_mov_b64 exec, -1
    v_exp_f32 v44, v44
    v_exp_f32 v45, v45
    v_exp_f32 v46, v46
    v_exp_f32 v47, v47
    v_exp_f32 v16, v16
    s_waitcnt lgkmcnt(2)
    v_exp_f32 v17, v17
    v_smfmac_f32_32x32x32_bf16 v[0:15], v[60:63], v[40:47], v64
    s_mov_b64 exec, s[26:27]
    ds_read_b128 v[60:63], v67 offset:37664
    s_mov_b64 exec, -1
    v_exp_f32 v18, v18
    v_exp_f32 v19, v19
    v_exp_f32 v20, v20
    v_exp_f32 v21, v21
    s_waitcnt lgkmcnt(2)
    v_exp_f32 v22, v22
    v_mfma_f32_32x32x16_bf16 v[32:47], v[52:55], v[48:51], 0
    ds_read_b128 v[52:55], v65 offset:41280
    v_exp_f32 v23, v23
    v_exp_f32 v24, v24
    s_lshl1_add_u32 m0, s74, 101920
    s_add_u32 s64, s70, 4096
    buffer_load_dwordx4 v251, s[44:47], s64 offen lds
    buffer_load_dwordx4 v251, s[44:47], s64 offen offset:1024 lds
    v_exp_f32 v25, v25
    v_exp_f32 v26, v26
    s_waitcnt lgkmcnt(2)
    v_exp_f32 v27, v27
    v_smfmac_f32_32x32x32_bf16 v[0:15], v[56:59], v[16:23], v64
    s_mov_b64 exec, s[26:27]
    ds_read_b128 v[56:59], v67 offset:39216
    s_mov_b64 exec, -1
    v_exp_f32 v28, v28
    v_exp_f32 v29, v29
    v_exp_f32 v30, v30
    v_exp_f32 v31, v31
    v_exp_f32 v32, v32
    s_waitcnt lgkmcnt(2)
    v_exp_f32 v33, v33
    v_smfmac_f32_32x32x32_bf16 v[0:15], v[60:63], v[24:31], v64
    s_mov_b64 exec, s[26:27]
    ds_read_b128 v[60:63], v67 offset:39728
    s_mov_b64 exec, -1
    v_exp_f32 v34, v34
    v_exp_f32 v35, v35
    v_exp_f32 v36, v36
    v_exp_f32 v37, v37
    s_waitcnt lgkmcnt(2)
    v_exp_f32 v38, v38
    v_mfma_f32_32x32x16_bf16 v[16:31], v[52:55], v[48:51], 0
    ds_read_b128 v[52:55], v65 offset:43344
    v_exp_f32 v39, v39
    v_exp_f32 v40, v40
    s_lshl1_add_u32 m0, s74, 103984
    s_add_u32 s64, s70, 6144
    buffer_load_dwordx4 v251, s[44:47], s64 offen lds
    buffer_load_dwordx4 v251, s[44:47], s64 offen offset:1024 lds
    v_exp_f32 v41, v41
    v_exp_f32 v42, v42
    s_waitcnt lgkmcnt(2)
    v_exp_f32 v43, v43
    v_smfmac_f32_32x32x32_bf16 v[0:15], v[56:59], v[32:39], v64
    s_mov_b64 exec, s[26:27]
    ds_read_b128 v[56:59], v67 offset:41280
    s_mov_b64 exec, -1
    v_exp_f32 v44, v44
    v_exp_f32 v45, v45
    v_exp_f32 v46, v46
    v_exp_f32 v47, v47
    s_setprio 2
    v_exp_f32 v16, v16
    s_waitcnt lgkmcnt(2)
    v_exp_f32 v17, v17
    v_smfmac_f32_32x32x32_bf16 v[0:15], v[60:63], v[40:47], v64
    s_mov_b64 exec, s[26:27]
    ds_read_b128 v[60:63], v67 offset:41792
    s_mov_b64 exec, -1
    v_exp_f32 v18, v18
    v_exp_f32 v19, v19
    v_exp_f32 v20, v20
    v_exp_f32 v21, v21
    s_waitcnt lgkmcnt(2)
    v_exp_f32 v22, v22
    v_mfma_f32_32x32x16_bf16 v[32:47], v[52:55], v[48:51], 0
    ds_read_b128 v[52:55], v65 offset:45408
    v_exp_f32 v23, v23
    v_exp_f32 v24, v24
    s_bitcmp1_b32 s63, 4
    s_cbranch_scc0 fz_kernel_r4
    v_lshrrev_b32 v76, 2, v250
    s_lshl4_add_u32 s64, s3, s57
    v_and_b32 v76, 8, v76
    s_mov_b32 exec_lo, 0x10000
    s_mov_b32 exec_hi, 0x10000
    s_add_u32 s64, s64, 0xbfffc0
    buffer_store_dwordx2 v[248:249], v76, s[44:47], s64 offen sc1
    s_mov_b64 exec, -1
fz_kernel_r4:
    v_exp_f32 v25, v25
    v_exp_f32 v26, v26
    s_waitcnt lgkmcnt(2)
    v_exp_f32 v27, v27
    v_smfmac_f32_32x32x32_bf16 v[0:15], v[56:59], v[16:23], v64
    s_mov_b64 exec, s[26:27]
    ds_read_b128 v[56:59], v67 offset:43344
    s_mov_b64 exec, -1
    v_exp_f32 v28, v28
    v_exp_f32 v29, v29
    v_mov_b32 v72, -1
    v_mov_b32 v73, -1
    v_mov_b32 v74, -1
    v_mov_b32 v75, -1
    buffer_store_dwordx4 v[72:75], v251, s[44:47], s59 offen sc1
    v_exp_f32 v30, v30
    v_exp_f32 v31, v31
    v_exp_f32 v32, v32
    s_waitcnt lgkmcnt(2)
    v_exp_f32 v33, v33
    v_smfmac_f32_32x32x32_bf16 v[0:15], v[60:63], v[24:31], v64
    s_mov_b64 exec, s[26:27]
    ds_read_b128 v[60:63], v67 offset:43856
    s_mov_b64 exec, -1
    v_exp_f32 v34, v34
    v_exp_f32 v35, v35
    s_bitcmp1_b32 s63, 3
    s_cbranch_scc0 fz_kernel_r5
    s_lshl_b32 s64, s55, 12
    v_bfe_u32 v76, v250, 2, 2
    v_lshrrev_b32 v77, 5, v250
    v_lshl_add_u32 v76, v77, 2, v76
    v_lshl_add_u32 v76, v76, 7, s64
    v_bfe_u32 v77, v250, 3, 1
    v_lshl_add_u32 v76, v77, 6, v76
    v_bfe_u32 v77, v250, 4, 1
    v_lshl_add_u32 v76, v77, 5, v76
    v_and_b32 v77, 3, v250
    v_lshl_add_u32 v76, v77, 3, v76
    v_xor_b32 v77, 64, v76
    s_waitcnt vmcnt(7)
    ds_read_b64_tr_b16 v[128:129], v76 offset:0
    ds_read_b64_tr_b16 v[130:131], v76 offset:1024
    ds_read_b64_tr_b16 v[132:133], v76 offset:2048
    ds_read_b64_tr_b16 v[134:135], v76 offset:3072
    ds_read_b64_tr_b16 v[136:137], v77 offset:0
    ds_read_b64_tr_b16 v[138:139], v77 offset:1024
    ds_read_b64_tr_b16 v[140:141], v77 offset:2048
    ds_read_b64_tr_b16 v[142:143], v77 offset:3072
fz_kernel_r5:
    v_exp_f32 v36, v36
    v_exp_f32 v37, v37
    s_waitcnt lgkmcnt(2)
    v_exp_f32 v38, v38
    v_mfma_f32_32x32x16_bf16 v[16:31], v[52:55], v[48:51], 0
    ds_read_b128 v[52:55], v65 offset:47472
    v_exp_f32 v39, v39
    v_exp_f32 v40, v40
    v_exp_f32 v41, v41
    v_exp_f32 v42, v42
    s_waitcnt lgkmcnt(2)
    v_exp_f32 v43, v43
    v_smfmac_f32_32x32x32_bf16 v[0:15], v[56:59], v[32:39], v64
    s_mov_b64 exec, s[26:27]
    ds_read_b128 v[56:59], v67 offset:45408
    s_mov_b64 exec, -1
    v_exp_f32 v44, v44
    v_exp_f32 v45, v45
    v_exp_f32 v46, v46
    v_exp_f32 v47, v47
    v_exp_f32 v16, v16
    s_waitcnt lgkmcnt(2)
    v_exp_f32 v17, v17
    v_smfmac_f32_32x32x32_bf16 v[0:15], v[60:63], v[40:47], v64
    s_mov_b64 exec, s[26:27]
    ds_read_b128 v[60:63], v67 offset:45920
    s_mov_b64 exec, -1
    v_exp_f32 v18, v18
    v_exp_f32 v19, v19
    s_bitcmp1_b32 s63, 0
    s_cbranch_scc0 fz_kernel_r6
    s_waitcnt vmcnt(9)
    s_mov_b64 exec, 1
    buffer_store_dword v249, off, s[44:47], s79 sc1
    s_mov_b64 exec, -1
fz_kernel_r6:
    s_bitcmp1_b32 s63, 3
    s_cbranch_scc0 fz_kernel_r7
    s_lshl2_add_u32 s64, s54, s55
    s_lshl4_add_u32 s64, s64, s52
    s_lshl_b32 s64, s64, 11
    s_waitcnt lgkmcnt(3)
    s_add_u32 s65, s64, 0x1400000
    buffer_store_dwordx4 v[128:131], v251, s[44:47], s65 offen sc1
    s_add_u32 s65, s64, 0x1400400
    buffer_store_dwordx4 v[132:135], v251, s[44:47], s65 offen sc1
    s_add_u32 s65, s64, 0x1410000
    buffer_store_dwordx4 v[136:139], v251, s[44:47], s65 offen sc1
    s_add_u32 s65, s64, 0x1410400
    buffer_store_dwordx4 v[140:143], v251, s[44:47], s65 offen sc1
fz_kernel_r7:
    v_exp_f32 v20, v20
    v_exp_f32 v21, v21
    s_waitcnt lgkmcnt(2)
    v_exp_f32 v22, v22
    v_mfma_f32_32x32x16_bf16 v[32:47], v[52:55], v[48:51], 0
    ds_read_b128 v[52:55], v65 offset:49536
    v_exp_f32 v23, v23
    v_exp_f32 v24, v24
    v_exp_f32 v25, v25
    v_exp_f32 v26, v26
    s_waitcnt lgkmcnt(2)
    v_exp_f32 v27, v27
    v_smfmac_f32_32x32x32_bf16 v[0:15], v[56:59], v[16:23], v64
    s_mov_b64 exec, s[26:27]
    ds_read_b128 v[56:59], v67 offset:47472
    s_mov_b64 exec, -1
    v_exp_f32 v28, v28
    v_exp_f32 v29, v29
    v_exp_f32 v30, v30
    v_exp_f32 v31, v31
    v_exp_f32 v32, v32
    s_waitcnt lgkmcnt(2)
    v_exp_f32 v33, v33
    v_smfmac_f32_32x32x32_bf16 v[0:15], v[60:63], v[24:31], v64
    s_mov_b64 exec, s[26:27]
    ds_read_b128 v[60:63], v67 offset:47984
    s_mov_b64 exec, -1
    v_exp_f32 v34, v34
    v_exp_f32 v35, v35
    v_exp_f32 v36, v36
    v_exp_f32 v37, v37
    s_waitcnt lgkmcnt(2)
    v_exp_f32 v38, v38
    v_mfma_f32_32x32x16_bf16 v[16:31], v[52:55], v[48:51], 0
    ds_read_b128 v[52:55], v65 offset:51600
    v_exp_f32 v39, v39
    v_exp_f32 v40, v40
    v_exp_f32 v41, v41
    v_exp_f32 v42, v42
    s_waitcnt lgkmcnt(2)
    v_exp_f32 v43, v43
    v_smfmac_f32_32x32x32_bf16 v[0:15], v[56:59], v[32:39], v64
    s_mov_b64 exec, s[26:27]
    ds_read_b128 v[56:59], v67 offset:49536
    s_mov_b64 exec, -1
    v_exp_f32 v44, v44
    v_exp_f32 v45, v45
    v_exp_f32 v46, v46
    v_exp_f32 v47, v47
    s_setprio 1
    v_exp_f32 v16, v16
    s_waitcnt lgkmcnt(2)
    v_exp_f32 v17, v17
    v_smfmac_f32_32x32x32_bf16 v[0:15], v[60:63], v[40:47], v64
    s_mov_b64 exec, s[26:27]
    ds_read_b128 v[60:63], v67 offset:50048
    s_mov_b64 exec, -1
    v_exp_f32 v18, v18
    v_exp_f32 v19, v19
    v_mov_b32 v242, 30720
    s_waitcnt vmcnt(1)
    s_mov_b64 exec, 1
    ds_add_u32 v242, v64 offset:0
    s_mov_b64 exec, -1
    v_exp_f32 v20, v20
    v_exp_f32 v21, v21
    s_waitcnt lgkmcnt(3)
    v_exp_f32 v22, v22
    v_mfma_f32_32x32x16_bf16 v[32:47], v[52:55], v[48:51], 0
    ds_read_b128 v[52:55], v65 offset:53664
    v_exp_f32 v23, v23
    v_exp_f32 v24, v24
    v_exp_f32 v25, v25
    v_exp_f32 v26, v26
    s_waitcnt lgkmcnt(3)
    v_exp_f32 v27, v27
    v_smfmac_f32_32x32x32_bf16 v[0:15], v[56:59], v[16:23], v64
    s_mov_b64 exec, s[26:27]
    ds_read_b128 v[56:59], v67 offset:51600
    s_mov_b64 exec, -1
    v_exp_f32 v28, v28
    v_exp_f32 v29, v29
    v_exp_f32 v30, v30
    v_exp_f32 v31, v31
    v_exp_f32 v32, v32
    s_waitcnt lgkmcnt(3)
    v_exp_f32 v33, v33
    v_smfmac_f32_32x32x32_bf16 v[0:15], v[60:63], v[24:31], v64
    s_mov_b64 exec, s[26:27]
    ds_read_b128 v[60:63], v67 offset:52112
    s_mov_b64 exec, -1
    v_exp_f32 v34, v34
    v_exp_f32 v35, v35
    v_exp_f32 v36, v36
    v_exp_f32 v37, v37
    s_waitcnt lgkmcnt(2)
    v_exp_f32 v38, v38
    v_mfma_f32_32x32x16_bf16 v[16:31], v[52:55], v[48:51], 0
    ds_read_b128 v[52:55], v65 offset:55728
    v_exp_f32 v39, v39
    v_exp_f32 v40, v40
    v_exp_f32 v41, v41
    v_exp_f32 v42, v42
    s_waitcnt lgkmcnt(2)
    v_exp_f32 v43, v43
    v_smfmac_f32_32x32x32_bf16 v[0:15], v[56:59], v[32:39], v64
    s_mov_b64 exec, s[26:27]
    ds_read_b128 v[56:59], v67 offset:53664
    s_mov_b64 exec, -1
    v_exp_f32 v44, v44
    v_exp_f32 v45, v45
    s_waitcnt vmcnt(0)
    s_mov_b64 exec, 1
    buffer_store_dword v249, off, s[44:47], s60 sc1
    s_mov_b64 exec, -1
    v_exp_f32 v46, v46
    v_exp_f32 v47, v47
    v_exp_f32 v16, v16
    s_waitcnt lgkmcnt(2)
    v_exp_f32 v17, v17
    v_smfmac_f32_32x32x32_bf16 v[0:15], v[60:63], v[40:47], v64
    s_mov_b64 exec, s[26:27]
    ds_read_b128 v[60:63], v67 offset:54176
    s_mov_b64 exec, -1
    v_exp_f32 v18, v18
    v_exp_f32 v19, v19
    s_bitcmp1_b32 s63, 3
    s_cbranch_scc0 fz_kernel_r8
    s_lshl1_add_u32 s64, s54, s55
    s_lshl4_add_u32 s64, s64, s52
    s_lshl_b32 s64, s64, 10
    s_add_u32 s64, s64, 0xc00080
    s_waitcnt vmcnt(1)
    s_mov_b64 exec, 1
    buffer_store_dword v249, off, s[44:47], s64 sc1
    s_mov_b64 exec, -1
fz_kernel_r8:
    v_exp_f32 v20, v20
    v_exp_f32 v21, v21
    s_waitcnt lgkmcnt(2)
    v_exp_f32 v22, v22
    v_mfma_f32_32x32x16_bf16 v[32:47], v[52:55], v[48:51], 0
    ds_read_b128 v[52:55], v65 offset:57792
    v_exp_f32 v23, v23
    v_exp_f32 v24, v24
    s_add_u32 m0, s74, 31744
    s_add_u32 s64, s70, 8192
    buffer_load_dwordx4 v251, s[44:47], s64 offen lds
    buffer_load_dwordx4 v251, s[44:47], s64 offen offset:1024 lds
    s_bitcmp1_b32 s63, 1
    s_cbranch_scc0 fz_kernel_r9
    v_and_b32 v243, 15, v250
    s_lshr_b32 s64, s52, 1
    s_lshl_b32 s92, s54, 9
    s_add_u32 s92, s92, s64
    s_lshr_b32 s64, s52, 2
    s_lshl_b32 s92, s92, 6
    v_lshlrev_b32 v243, 10, v243
    s_add_u32 s92, s92, 0x1100200
    buffer_load_dword v240, v243, s[44:47], s92 offen sc1
    s_lshl_b32 s96, s54, 2
    s_add_u32 s96, s96, s64
    s_mul_i32 s96, s96, 34816
    s_and_b32 s64, s52, 3
    s_mul_i32 s64, s64, 544
    s_add_u32 s96, s96, s64
fz_kernel_r9:
    v_exp_f32 v25, v25
    v_exp_f32 v26, v26
    s_waitcnt lgkmcnt(2)
    v_exp_f32 v27, v27
    v_smfmac_f32_32x32x32_bf16 v[0:15], v[56:59], v[16:23], v64
    s_mov_b64 exec, s[26:27]
    ds_read_b128 v[56:59], v67 offset:55728
    s_mov_b64 exec, -1
    v_exp_f32 v28, v28
    v_exp_f32 v29, v29
    v_exp_f32 v30, v30
    v_exp_f32 v31, v31
    v_exp_f32 v32, v32
    s_waitcnt lgkmcnt(2)
    v_exp_f32 v33, v33
    v_smfmac_f32_32x32x32_bf16 v[0:15], v[60:63], v[24:31], v64
    s_mov_b64 exec, s[26:27]
    ds_read_b128 v[60:63], v67 offset:56240
    s_mov_b64 exec, -1
    v_exp_f32 v34, v34
    v_exp_f32 v35, v35
    ds_read_b32 v79, v242 offset:0
    v_exp_f32 v36, v36
    v_exp_f32 v37, v37
    s_waitcnt lgkmcnt(3)
    v_exp_f32 v38, v38
    v_mfma_f32_32x32x16_bf16 v[16:31], v[52:55], v[48:51], 0
    ds_read_b128 v[52:55], v65 offset:59856
    v_exp_f32 v39, v39
    v_exp_f32 v40, v40
    s_add_u32 m0, s74, 33808
    s_add_u32 s64, s70, 10240
    buffer_load_dwordx4 v251, s[44:47], s64 offen lds
    buffer_load_dwordx4 v251, s[44:47], s64 offen offset:1024 lds
    v_exp_f32 v41, v41
    v_exp_f32 v42, v42
    s_waitcnt lgkmcnt(3)
    v_exp_f32 v43, v43
    v_smfmac_f32_32x32x32_bf16 v[0:15], v[56:59], v[32:39], v64
    s_mov_b64 exec, s[26:27]
    ds_read_b128 v[56:59], v67 offset:57792
    s_mov_b64 exec, -1
    v_exp_f32 v44, v44
    v_exp_f32 v45, v45
    v_exp_f32 v46, v46
    v_exp_f32 v47, v47
    s_setprio 0
    v_exp_f32 v16, v16
    s_waitcnt lgkmcnt(3)
    v_exp_f32 v17, v17
    v_smfmac_f32_32x32x32_bf16 v[0:15], v[60:63], v[40:47], v64
    s_mov_b64 exec, s[26:27]
    ds_read_b128 v[60:63], v67 offset:58304
    s_mov_b64 exec, -1
    v_exp_f32 v18, v18
    v_exp_f32 v19, v19
    v_exp_f32 v20, v20
    v_exp_f32 v21, v21
    s_waitcnt lgkmcnt(2)
    v_exp_f32 v22, v22
    v_mfma_f32_32x32x16_bf16 v[32:47], v[52:55], v[48:51], 0
    ds_read_b128 v[52:55], v65 offset:61920
    v_exp_f32 v23, v23
    v_exp_f32 v24, v24
    v_exp_f32 v25, v25
    v_exp_f32 v26, v26
    s_waitcnt lgkmcnt(2)
    v_exp_f32 v27, v27
    v_smfmac_f32_32x32x32_bf16 v[0:15], v[56:59], v[16:23], v64
    s_mov_b64 exec, s[26:27]
    ds_read_b128 v[56:59], v67 offset:59856
    s_mov_b64 exec, -1
    v_exp_f32 v28, v28
    v_exp_f32 v29, v29
    v_exp_f32 v30, v30
    v_exp_f32 v31, v31
    v_exp_f32 v32, v32
    s_waitcnt lgkmcnt(2)
    v_exp_f32 v33, v33
    v_smfmac_f32_32x32x32_bf16 v[0:15], v[60:63], v[24:31], v64
    s_mov_b64 exec, s[26:27]
    ds_read_b128 v[60:63], v67 offset:60368
    s_mov_b64 exec, -1
    v_exp_f32 v34, v34
    s_bitcmp1_b32 s63, 1
    s_cbranch_scc0 fz_kernel_r10
    s_waitcnt vmcnt(2)
    v_cmp_ne_u32 vcc, v249, v240
    s_cbranch_vccnz fz_kernel_l2s
fz_kernel_l2k:
fz_kernel_r10:
    v_exp_f32 v35, v35
    s_waitcnt lgkmcnt(6)
    v_cmp_ne_u32 vcc, 0xeeeeeee8, v79
    s_cbranch_vccnz fz_kernel_cn0s
fz_kernel_cn0k:
    s_bitcmp1_b32 s63, 1
    s_cbranch_scc0 fz_kernel_r11
    s_add_u32 s64, s96, 0xa00000
    buffer_load_dwordx4 v[96:99], v241, s[44:47], s64 offen offset:0
    buffer_load_dwordx4 v[100:103], v241, s[44:47], s64 offen offset:2176
    s_add_u32 s64, s96, 0xa01100
    buffer_load_dwordx4 v[104:107], v241, s[44:47], s64 offen offset:0
    buffer_load_dwordx4 v[108:111], v241, s[44:47], s64 offen offset:2176
fz_kernel_r11:
    v_exp_f32 v36, v36
    v_exp_f32 v37, v37
    s_waitcnt lgkmcnt(2)
    v_exp_f32 v38, v38
    v_mfma_f32_32x32x16_bf16 v[16:31], v[52:55], v[48:51], 0
    ds_read_b128 v[52:55], v65 offset:63984
    v_exp_f32 v39, v39
    v_exp_f32 v40, v40
    v_exp_f32 v41, v41
    v_exp_f32 v42, v42
    s_waitcnt lgkmcnt(2)
    v_exp_f32 v43, v43
    v_smfmac_f32_32x32x32_bf16 v[0:15], v[56:59], v[32:39], v64
    s_mov_b64 exec, s[26:27]
    ds_read_b128 v[56:59], v67 offset:61920
    s_mov_b64 exec, -1
    v_exp_f32 v44, v44
    v_exp_f32 v45, v45
    s_bitcmp1_b32 s63, 1
    s_cbranch_scc0 fz_kernel_r12
    s_add_u32 s64, s96, 0xa02200
    buffer_load_dwordx4 v[112:115], v241, s[44:47], s64 offen offset:0
    buffer_load_dwordx4 v[116:119], v241, s[44:47], s64 offen offset:2176
    s_add_u32 s64, s96, 0xa03300
    buffer_load_dwordx4 v[120:123], v241, s[44:47], s64 offen offset:0
    buffer_load_dwordx4 v[124:127], v241, s[44:47], s64 offen offset:2176
fz_kernel_r12:
    v_exp_f32 v46, v46
    v_exp_f32 v47, v47
    v_exp_f32 v16, v16
    s_waitcnt lgkmcnt(2)
    v_exp_f32 v17, v17
    v_smfmac_f32_32x32x32_bf16 v[0:15], v[60:63], v[40:47], v64
    s_mov_b64 exec, s[26:27]
    ds_read_b128 v[60:63], v67 offset:62432
    s_mov_b64 exec, -1
    v_exp_f32 v18, v18
    v_exp_f32 v19, v19
    s_bitcmp1_b32 s63, 1
    s_cbranch_scc0 fz_kernel_r13
    s_add_u32 s64, s96, 0xa04400
    buffer_load_dwordx4 v[144:147], v241, s[44:47], s64 offen offset:0
    buffer_load_dwordx4 v[148:151], v241, s[44:47], s64 offen offset:2176
    s_add_u32 s64, s96, 0xa05500
    buffer_load_dwordx4 v[152:155], v241, s[44:47], s64 offen offset:0
    buffer_load_dwordx4 v[156:159], v241, s[44:47], s64 offen offset:2176
fz_kernel_r13:
    v_exp_f32 v20, v20
    v_exp_f32 v21, v21
    s_waitcnt lgkmcnt(2)
    v_exp_f32 v22, v22
    v_mfma_f32_32x32x16_bf16 v[32:47], v[52:55], v[48:51], 0
    ds_read_b128 v[52:55], v66 offset:0
    v_exp_f32 v23, v23
    v_exp_f32 v24, v24
    v_exp_f32 v25, v25
    v_exp_f32 v26, v26
    s_waitcnt lgkmcnt(2)
    v_exp_f32 v27, v27
    v_smfmac_f32_32x32x32_bf16 v[0:15], v[56:59], v[16:23], v64
    s_mov_b64 exec, s[26:27]
    ds_read_b128 v[56:59], v67 offset:63984
    s_mov_b64 exec, -1
    v_exp_f32 v28, v28
    v_exp_f32 v29, v29
    s_bitcmp1_b32 s63, 1
    s_cbranch_scc0 fz_kernel_r14
    s_add_u32 s64, s96, 0xa06600
    buffer_load_dwordx4 v[160:163], v241, s[44:47], s64 offen offset:0
    buffer_load_dwordx4 v[164:167], v241, s[44:47], s64 offen offset:2176
    s_add_u32 s64, s96, 0xa07700
    buffer_load_dwordx4 v[168:171], v241, s[44:47], s64 offen offset:0
    buffer_load_dwordx4 v[172:175], v241, s[44:47], s64 offen offset:2176
fz_kernel_r14:
    v_exp_f32 v30, v30
    v_exp_f32 v31, v31
    v_exp_f32 v32, v32
    s_waitcnt lgkmcnt(2)
    v_exp_f32 v33, v33
    v_smfmac_f32_32x32x32_bf16 v[0:15], v[60:63], v[24:31], v64
    s_mov_b64 exec, s[26:27]
    ds_read_b128 v[60:63], v67 offset:64496
    s_mov_b64 exec, -1
    v_exp_f32 v34, v34
    v_exp_f32 v35, v35
    v_exp_f32 v36, v36
    v_exp_f32 v37, v37
    s_waitcnt lgkmcnt(2)
    v_exp_f32 v38, v38
    v_mfma_f32_32x32x16_bf16 v[16:31], v[52:55], v[48:51], 0
    ds_read_b128 v[52:55], v66 offset:2064
    v_exp_f32 v39, v39
    v_exp_f32 v40, v40
    v_exp_f32 v41, v41
    v_exp_f32 v42, v42
    s_waitcnt lgkmcnt(2)
    v_exp_f32 v43, v43
    v_smfmac_f32_32x32x32_bf16 v[0:15], v[56:59], v[32:39], v64
    s_mov_b64 exec, s[26:27]
    ds_read_b128 v[56:59], v68 offset:0
    s_mov_b64 exec, -1
    v_exp_f32 v44, v44
    v_exp_f32 v45, v45
    v_exp_f32 v46, v46
    v_exp_f32 v47, v47
    s_setprio 3
    v_exp_f32 v16, v16
    s_waitcnt lgkmcnt(2)
    v_exp_f32 v17, v17
    v_smfmac_f32_32x32x32_bf16 v[0:15], v[60:63], v[40:47], v64
    s_mov_b64 exec, s[26:27]
    ds_read_b128 v[60:63], v68 offset:512
    s_mov_b64 exec, -1
    v_exp_f32 v18, v18
    v_exp_f32 v19, v19
    v_exp_f32 v20, v20
    v_exp_f32 v21, v21
    s_waitcnt lgkmcnt(2)
    v_exp_f32 v22, v22
    v_mfma_f32_32x32x16_bf16 v[32:47], v[52:55], v[48:51], 0
    ds_read_b128 v[52:55], v66 offset:4128
    v_exp_f32 v23, v23
    v_exp_f32 v24, v24
    v_exp_f32 v25, v25
    v_exp_f32 v26, v26
    s_waitcnt lgkmcnt(2)
    v_exp_f32 v27, v27
    v_smfmac_f32_32x32x32_bf16 v[0:15], v[56:59], v[16:23], v64
    s_mov_b64 exec, s[26:27]
    ds_read_b128 v[56:59], v68 offset:2064
    s_mov_b64 exec, -1
    v_exp_f32 v28, v28
    v_exp_f32 v29, v29
    v_exp_f32 v30, v30
    v_exp_f32 v31, v31
    v_exp_f32 v32, v32
    s_waitcnt lgkmcnt(2)
    v_exp_f32 v33, v33
    v_smfmac_f32_32x32x32_bf16 v[0:15], v[60:63], v[24:31], v64
    s_mov_b64 exec, s[26:27]
    ds_read_b128 v[60:63], v68 offset:2576
    s_mov_b64 exec, -1
    v_exp_f32 v34, v34
    v_exp_f32 v35, v35
    v_exp_f32 v36, v36
    v_exp_f32 v37, v37
    s_waitcnt lgkmcnt(2)
    v_exp_f32 v38, v38
    v_mfma_f32_32x32x16_bf16 v[16:31], v[52:55], v[48:51], 0
    ds_read_b128 v[52:55], v66 offset:6192
    v_exp_f32 v39, v39
    v_exp_f32 v40, v40
    v_exp_f32 v41, v41
    v_exp_f32 v42, v42
    s_waitcnt lgkmcnt(2)
    v_exp_f32 v43, v43
    v_smfmac_f32_32x32x32_bf16 v[0:15], v[56:59], v[32:39], v64
    s_mov_b64 exec, s[26:27]
    ds_read_b128 v[56:59], v68 offset:4128
    s_mov_b64 exec, -1
    v_exp_f32 v44, v44
    v_exp_f32 v45, v45
    v_exp_f32 v46, v46
    v_exp_f32 v47, v47
    v_exp_f32 v16, v16
    s_waitcnt lgkmcnt(2)
    v_exp_f32 v17, v17
    v_smfmac_f32_32x32x32_bf16 v[0:15], v[60:63], v[40:47], v64
    s_mov_b64 exec, s[26:27]
    ds_read_b128 v[60:63], v68 offset:4640
    s_mov_b64 exec, -1
    v_exp_f32 v18, v18
    v_exp_f32 v19, v19
    s_waitcnt vmcnt(0)
    s_mov_b64 exec, 1
    ds_add_u32 v242, v64 offset:64
    s_mov_b64 exec, -1
    s_bitcmp1_b32 s63, 1
    s_cbranch_scc0 fz_kernel_r15
    s_waitcnt vmcnt(0)
    v_pk_add_f32 v[96:97], v[96:97], v[144:145]
    v_pk_add_f32 v[98:99], v[98:99], v[146:147]
    v_pk_add_f32 v[100:101], v[100:101], v[148:149]
    v_pk_add_f32 v[102:103], v[102:103], v[150:151]
    v_pk_add_f32 v[104:105], v[104:105], v[152:153]
    v_pk_add_f32 v[106:107], v[106:107], v[154:155]
    v_pk_add_f32 v[108:109], v[108:109], v[156:157]
    v_pk_add_f32 v[110:111], v[110:111], v[158:159]
    v_pk_add_f32 v[112:113], v[112:113], v[160:161]
    v_pk_add_f32 v[114:115], v[114:115], v[162:163]
    v_pk_add_f32 v[116:117], v[116:117], v[164:165]
    v_pk_add_f32 v[118:119], v[118:119], v[166:167]
    v_pk_add_f32 v[120:121], v[120:121], v[168:169]
    v_pk_add_f32 v[122:123], v[122:123], v[170:171]
    v_pk_add_f32 v[124:125], v[124:125], v[172:173]
    v_pk_add_f32 v[126:127], v[126:127], v[174:175]
fz_kernel_r15:
    v_exp_f32 v20, v20
    v_exp_f32 v21, v21
    s_waitcnt lgkmcnt(3)
    v_exp_f32 v22, v22
    v_mfma_f32_32x32x16_bf16 v[32:47], v[52:55], v[48:51], 0
    ds_read_b128 v[52:55], v66 offset:8256
    v_exp_f32 v23, v23
    v_exp_f32 v24, v24
    v_exp_f32 v25, v25
    v_exp_f32 v26, v26
    s_waitcnt lgkmcnt(3)
    v_exp_f32 v27, v27
    v_smfmac_f32_32x32x32_bf16 v[0:15], v[56:59], v[16:23], v64
    s_mov_b64 exec, s[26:27]
    ds_read_b128 v[56:59], v68 offset:6192
    s_mov_b64 exec, -1
    v_exp_f32 v28, v28
    v_exp_f32 v29, v29
    s_bitcmp1_b32 s63, 1
    s_cbranch_scc0 fz_kernel_r16
    v_pk_add_f32 v[96:97], v[96:97], v[112:113]
    v_pk_add_f32 v[98:99], v[98:99], v[114:115]
    v_pk_add_f32 v[100:101], v[100:101], v[116:117]
    v_pk_add_f32 v[102:103], v[102:103], v[118:119]
    v_pk_add_f32 v[104:105], v[104:105], v[120:121]
    v_pk_add_f32 v[106:107], v[106:107], v[122:123]
    v_pk_add_f32 v[108:109], v[108:109], v[124:125]
    v_pk_add_f32 v[110:111], v[110:111], v[126:127]
    v_pk_add_f32 v[96:97], v[96:97], v[104:105]
    v_pk_add_f32 v[98:99], v[98:99], v[106:107]
    v_pk_add_f32 v[100:101], v[100:101], v[108:109]
    v_pk_add_f32 v[102:103], v[102:103], v[110:111]
    v_pk_add_f32 v[96:97], v[96:97], v[100:101]
    v_pk_add_f32 v[98:99], v[98:99], v[102:103]
    s_andn2_b32 s64, s57, 0x4000
    s_add_u32 s64, s64, 0xc00100
    v_cvt_pk_bf16_f32 v102, v96, v97
    v_cvt_pk_bf16_f32 v103, v98, v99
    v_mov_b32 v100, v249
    v_mov_b32 v104, v249
    s_bitcmp1_b32 s52, 0
    s_mov_b32 exec_lo, 0x1ffff
    s_mov_b32 exec_hi, 0x1ffff
    s_cbranch_scc1 fz_kernel_kso
    buffer_store_dwordx4 v[100:103], v241, s[44:47], s64 offen sc1
    s_branch fz_kernel_kse
fz_kernel_kso:
    buffer_store_dwordx4 v[102:105], v241, s[44:47], s64 offen sc1
fz_kernel_kse:
    s_mov_b64 exec, -1
fz_kernel_r16:
    v_exp_f32 v30, v30
    v_exp_f32 v31, v31
    v_exp_f32 v32, v32
    s_waitcnt lgkmcnt(3)
    v_exp_f32 v33, v33
    v_smfmac_f32_32x32x32_bf16 v[0:15], v[60:63], v[24:31], v64
    s_mov_b64 exec, s[26:27]
    ds_read_b128 v[60:63], v68 offset:6704
    s_mov_b64 exec, -1
    v_exp_f32 v34, v34
    v_exp_f32 v35, v35
    v_exp_f32 v36, v36
    v_exp_f32 v37, v37
    s_waitcnt lgkmcnt(2)
    v_exp_f32 v38, v38
    v_mfma_f32_32x32x16_bf16 v[16:31], v[52:55], v[48:51], 0
    ds_read_b128 v[52:55], v66 offset:10320
    v_exp_f32 v39, v39
    v_exp_f32 v40, v40
    v_exp_f32 v41, v41
    v_exp_f32 v42, v42
    s_waitcnt lgkmcnt(2)
    v_exp_f32 v43, v43
    v_smfmac_f32_32x32x32_bf16 v[0:15], v[56:59], v[32:39], v64
    s_mov_b64 exec, s[26:27]
    ds_read_b128 v[56:59], v68 offset:8256
    s_mov_b64 exec, -1
    v_exp_f32 v44, v44
    v_exp_f32 v45, v45
    v_exp_f32 v46, v46
    v_exp_f32 v47, v47
    s_setprio 2
    v_exp_f32 v16, v16
    s_waitcnt lgkmcnt(2)
    v_exp_f32 v17, v17
    v_smfmac_f32_32x32x32_bf16 v[0:15], v[60:63], v[40:47], v64
    s_mov_b64 exec, s[26:27]
    ds_read_b128 v[60:63], v68 offset:8768
    s_mov_b64 exec, -1
    v_exp_f32 v18, v18
    v_exp_f32 v19, v19
    s_lshl1_add_u32 s92, s75, s77
    v_and_b32 v243, 0x13, v250
    s_lshl3_add_u32 s92, s92, s76
    s_lshl_b32 s92, s92, 12
    v_lshlrev_b32 v243, 10, v243
    s_add_u32 s92, s92, 0xc00080
    buffer_load_dword v240, v243, s[44:47], s92 offen sc1
    v_exp_f32 v20, v20
    v_exp_f32 v21, v21
    s_waitcnt lgkmcnt(2)
    v_exp_f32 v22, v22
    v_mfma_f32_32x32x16_bf16 v[32:47], v[52:55], v[48:51], 0
    ds_read_b128 v[52:55], v66 offset:12384
    v_exp_f32 v23, v23
    v_exp_f32 v24, v24
    v_exp_f32 v25, v25
    v_exp_f32 v26, v26
    s_waitcnt lgkmcnt(2)
    v_exp_f32 v27, v27
    v_smfmac_f32_32x32x32_bf16 v[0:15], v[56:59], v[16:23], v64
    s_mov_b64 exec, s[26:27]
    ds_read_b128 v[56:59], v68 offset:10320
    s_mov_b64 exec, -1
    v_exp_f32 v28, v28
    v_exp_f32 v29, v29
    v_exp_f32 v30, v30
    v_exp_f32 v31, v31
    v_exp_f32 v32, v32
    s_waitcnt lgkmcnt(2)
    v_exp_f32 v33, v33
    v_smfmac_f32_32x32x32_bf16 v[0:15], v[60:63], v[24:31], v64
    s_mov_b64 exec, s[26:27]
    ds_read_b128 v[60:63], v68 offset:10832
    s_mov_b64 exec, -1
    v_exp_f32 v34, v34
    v_exp_f32 v35, v35
    v_exp_f32 v36, v36
    v_exp_f32 v37, v37
    s_waitcnt lgkmcnt(2)
    v_exp_f32 v38, v38
    v_mfma_f32_32x32x16_bf16 v[16:31], v[52:55], v[48:51], 0
    ds_read_b128 v[52:55], v66 offset:14448
    v_exp_f32 v39, v39
    v_exp_f32 v40, v40
    v_exp_f32 v41, v41
    v_exp_f32 v42, v42
    s_waitcnt lgkmcnt(2)
    v_exp_f32 v43, v43
    v_smfmac_f32_32x32x32_bf16 v[0:15], v[56:59], v[32:39], v64
    s_mov_b64 exec, s[26:27]
    ds_read_b128 v[56:59], v68 offset:12384
    s_mov_b64 exec, -1
    v_exp_f32 v44, v44
    v_exp_f32 v45, v45
    v_exp_f32 v46, v46
    v_exp_f32 v47, v47
    v_exp_f32 v16, v16
    s_waitcnt lgkmcnt(2)
    v_exp_f32 v17, v17
    v_smfmac_f32_32x32x32_bf16 v[0:15], v[60:63], v[40:47], v64
    s_mov_b64 exec, s[26:27]
    ds_read_b128 v[60:63], v68 offset:12896
    s_mov_b64 exec, -1
    v_exp_f32 v18, v18
    v_exp_f32 v19, v19
    v_exp_f32 v20, v20
    v_exp_f32 v21, v21
    s_waitcnt lgkmcnt(2)
    v_exp_f32 v22, v22
    v_mfma_f32_32x32x16_bf16 v[32:47], v[52:55], v[48:51], 0
    ds_read_b128 v[52:55], v66 offset:16512
    v_exp_f32 v23, v23
    v_exp_f32 v24, v24
    v_exp_f32 v25, v25
    v_exp_f32 v26, v26
    s_waitcnt lgkmcnt(2)
    v_exp_f32 v27, v27
    v_smfmac_f32_32x32x32_bf16 v[0:15], v[56:59], v[16:23], v64
    s_mov_b64 exec, s[26:27]
    ds_read_b128 v[56:59], v68 offset:14448
    s_mov_b64 exec, -1
    v_exp_f32 v28, v28
    v_exp_f32 v29, v29
    v_exp_f32 v30, v30
    v_exp_f32 v31, v31
    v_exp_f32 v32, v32
    s_waitcnt lgkmcnt(2)
    v_exp_f32 v33, v33
    v_smfmac_f32_32x32x32_bf16 v[0:15], v[60:63], v[24:31], v64
    s_mov_b64 exec, s[26:27]
    ds_read_b128 v[60:63], v68 offset:14960
    s_mov_b64 exec, -1
    v_exp_f32 v34, v34
    s_waitcnt vmcnt(0)
    v_cmp_ne_u32 vcc, v249, v240
    s_cbranch_vccnz fz_kernel_wfs
fz_kernel_wfk:
    v_exp_f32 v35, v35
    v_exp_f32 v36, v36
    v_exp_f32 v37, v37
    s_waitcnt lgkmcnt(2)
    v_exp_f32 v38, v38
    v_mfma_f32_32x32x16_bf16 v[16:31], v[52:55], v[48:51], 0
    ds_read_b128 v[52:55], v66 offset:18576
    v_exp_f32 v39, v39
    v_exp_f32 v40, v40
    v_exp_f32 v41, v41
    v_exp_f32 v42, v42
    s_waitcnt lgkmcnt(2)
    v_exp_f32 v43, v43
    v_smfmac_f32_32x32x32_bf16 v[0:15], v[56:59], v[32:39], v64
    s_mov_b64 exec, s[26:27]
    ds_read_b128 v[56:59], v68 offset:16512
    s_mov_b64 exec, -1
    v_exp_f32 v44, v44
    v_exp_f32 v45, v45
    v_exp_f32 v46, v46
    v_exp_f32 v47, v47
    s_setprio 1
    v_exp_f32 v16, v16
    s_waitcnt lgkmcnt(2)
    v_exp_f32 v17, v17
    v_smfmac_f32_32x32x32_bf16 v[0:15], v[60:63], v[40:47], v64
    s_mov_b64 exec, s[26:27]
    ds_read_b128 v[60:63], v68 offset:17024
    s_mov_b64 exec, -1
    v_exp_f32 v18, v18
    v_exp_f32 v19, v19
    v_exp_f32 v20, v20
    v_exp_f32 v21, v21
    s_waitcnt lgkmcnt(2)
    v_exp_f32 v22, v22
    v_mfma_f32_32x32x16_bf16 v[32:47], v[52:55], v[48:51], 0
    ds_read_b128 v[52:55], v66 offset:20640
    v_exp_f32 v23, v23
    v_exp_f32 v24, v24
    v_exp_f32 v25, v25
    v_exp_f32 v26, v26
    s_waitcnt lgkmcnt(2)
    v_exp_f32 v27, v27
    v_smfmac_f32_32x32x32_bf16 v[0:15], v[56:59], v[16:23], v64
    s_mov_b64 exec, s[26:27]
    ds_read_b128 v[56:59], v68 offset:18576
    s_mov_b64 exec, -1
    v_exp_f32 v28, v28
    v_exp_f32 v29, v29
    v_exp_f32 v30, v30
    v_exp_f32 v31, v31
    v_exp_f32 v32, v32
    s_waitcnt lgkmcnt(2)
    v_exp_f32 v33, v33
    v_smfmac_f32_32x32x32_bf16 v[0:15], v[60:63], v[24:31], v64
    s_mov_b64 exec, s[26:27]
    ds_read_b128 v[60:63], v68 offset:19088
    s_mov_b64 exec, -1
    v_exp_f32 v34, v34
    v_exp_f32 v35, v35
    v_exp_f32 v36, v36
    v_exp_f32 v37, v37
    s_waitcnt lgkmcnt(2)
    v_exp_f32 v38, v38
    v_mfma_f32_32x32x16_bf16 v[16:31], v[52:55], v[48:51], 0
    ds_read_b128 v[52:55], v66 offset:22704
    v_exp_f32 v39, v39
    v_exp_f32 v40, v40
    s_add_u32 s64, s71, 0x8000
    buffer_load_dwordx4 v[176:179], v251, s[44:47], s64 offen
    v_exp_f32 v41, v41
    v_exp_f32 v42, v42
    s_waitcnt lgkmcnt(2)
    v_exp_f32 v43, v43
    v_smfmac_f32_32x32x32_bf16 v[0:15], v[56:59], v[32:39], v64
    s_mov_b64 exec, s[26:27]
    ds_read_b128 v[56:59], v68 offset:20640
    s_mov_b64 exec, -1
    v_exp_f32 v44, v44
    v_exp_f32 v45, v45
    s_add_u32 s64, s71, 0x18000
    buffer_load_dwordx4 v[180:183], v251, s[44:47], s64 offen
    v_exp_f32 v46, v46
    v_exp_f32 v47, v47
    v_exp_f32 v16, v16
    s_waitcnt lgkmcnt(2)
    v_exp_f32 v17, v17
    v_smfmac_f32_32x32x32_bf16 v[0:15], v[60:63], v[40:47], v64
    s_mov_b64 exec, s[26:27]
    ds_read_b128 v[60:63], v68 offset:21152
    s_mov_b64 exec, -1
    v_exp_f32 v18, v18
    v_exp_f32 v19, v19
    v_exp_f32 v20, v20
    v_exp_f32 v21, v21
    s_waitcnt lgkmcnt(2)
    v_exp_f32 v22, v22
    v_mfma_f32_32x32x16_bf16 v[32:47], v[52:55], v[48:51], 0
    ds_read_b128 v[52:55], v66 offset:24768
    v_exp_f32 v23, v23
    v_exp_f32 v24, v24
    s_add_u32 s64, s71, 0x8400
    buffer_load_dwordx4 v[184:187], v251, s[44:47], s64 offen
    v_exp_f32 v25, v25
    v_exp_f32 v26, v26
    s_waitcnt lgkmcnt(2)
    v_exp_f32 v27, v27
    v_smfmac_f32_32x32x32_bf16 v[0:15], v[56:59], v[16:23], v64
    s_mov_b64 exec, s[26:27]
    ds_read_b128 v[56:59], v68 offset:22704
    s_mov_b64 exec, -1
    v_exp_f32 v28, v28
    v_exp_f32 v29, v29
    s_add_u32 s64, s71, 0x18400
    buffer_load_dwordx4 v[188:191], v251, s[44:47], s64 offen
    v_exp_f32 v30, v30
    v_exp_f32 v31, v31
    v_exp_f32 v32, v32
    s_waitcnt lgkmcnt(2)
    v_exp_f32 v33, v33
    v_smfmac_f32_32x32x32_bf16 v[0:15], v[60:63], v[24:31], v64
    s_mov_b64 exec, s[26:27]
    ds_read_b128 v[60:63], v68 offset:23216
    s_mov_b64 exec, -1
    v_exp_f32 v34, v34
    v_exp_f32 v35, v35
    v_exp_f32 v36, v36
    v_exp_f32 v37, v37
    s_waitcnt lgkmcnt(2)
    v_exp_f32 v38, v38
    v_mfma_f32_32x32x16_bf16 v[16:31], v[52:55], v[48:51], 0
    ds_read_b128 v[52:55], v66 offset:26832
    v_exp_f32 v39, v39
    v_exp_f32 v40, v40
    s_add_u32 s64, s71, 0x8800
    buffer_load_dwordx4 v[192:195], v251, s[44:47], s64 offen
    v_exp_f32 v41, v41
    v_exp_f32 v42, v42
    s_waitcnt lgkmcnt(2)
    v_exp_f32 v43, v43
    v_smfmac_f32_32x32x32_bf16 v[0:15], v[56:59], v[32:39], v64
    s_mov_b64 exec, s[26:27]
    ds_read_b128 v[56:59], v68 offset:24768
    s_mov_b64 exec, -1
    v_exp_f32 v44, v44
    v_exp_f32 v45, v45
    s_add_u32 s64, s71, 0x18800
    buffer_load_dwordx4 v[196:199], v251, s[44:47], s64 offen
    v_exp_f32 v46, v46
    v_exp_f32 v47, v47
    s_setprio 0
    v_exp_f32 v16, v16
    s_waitcnt lgkmcnt(2)
    v_exp_f32 v17, v17
    v_smfmac_f32_32x32x32_bf16 v[0:15], v[60:63], v[40:47], v64
    s_mov_b64 exec, s[26:27]
    ds_read_b128 v[60:63], v68 offset:25280
    s_mov_b64 exec, -1
    v_exp_f32 v18, v18
    v_exp_f32 v19, v19
    v_exp_f32 v20, v20
    v_exp_f32 v21, v21
    s_waitcnt lgkmcnt(2)
    v_exp_f32 v22, v22
    v_mfma_f32_32x32x16_bf16 v[32:47], v[52:55], v[48:51], 0
    ds_read_b128 v[52:55], v66 offset:28896
    v_exp_f32 v23, v23
    v_exp_f32 v24, v24
    s_add_u32 s64, s71, 0x8c00
    buffer_load_dwordx4 v[200:203], v251, s[44:47], s64 offen
    v_exp_f32 v25, v25
    v_exp_f32 v26, v26
    s_waitcnt lgkmcnt(2)
    v_exp_f32 v27, v27
    v_smfmac_f32_32x32x32_bf16 v[0:15], v[56:59], v[16:23], v64
    s_mov_b64 exec, s[26:27]
    ds_read_b128 v[56:59], v68 offset:26832
    s_mov_b64 exec, -1
    v_exp_f32 v28, v28
    v_exp_f32 v29, v29
    s_add_u32 s64, s71, 0x18c00
    buffer_load_dwordx4 v[204:207], v251, s[44:47], s64 offen
    v_exp_f32 v30, v30
    v_exp_f32 v31, v31
    v_exp_f32 v32, v32
    s_waitcnt lgkmcnt(2)
    v_exp_f32 v33, v33
    v_smfmac_f32_32x32x32_bf16 v[0:15], v[60:63], v[24:31], v64
    s_mov_b64 exec, s[26:27]
    ds_read_b128 v[60:63], v68 offset:27344
    s_mov_b64 exec, -1
    v_exp_f32 v34, v34
    v_exp_f32 v35, v35
    v_exp_f32 v36, v36
    v_exp_f32 v37, v37
    s_waitcnt lgkmcnt(2)
    v_exp_f32 v38, v38
    v_mfma_f32_32x32x16_bf16 v[16:31], v[52:55], v[48:51], 0
    ds_read_b128 v[52:55], v66 offset:30960
    v_exp_f32 v39, v39
    v_exp_f32 v40, v40
    v_exp_f32 v41, v41
    v_exp_f32 v42, v42
    s_waitcnt lgkmcnt(2)
    v_exp_f32 v43, v43
    v_smfmac_f32_32x32x32_bf16 v[0:15], v[56:59], v[32:39], v64
    s_mov_b64 exec, s[26:27]
    ds_read_b128 v[56:59], v68 offset:28896
    s_mov_b64 exec, -1
    v_exp_f32 v44, v44
    v_exp_f32 v45, v45
    v_exp_f32 v46, v46
    v_exp_f32 v47, v47
    v_exp_f32 v16, v16
    s_waitcnt lgkmcnt(2)
    v_exp_f32 v17, v17
    v_smfmac_f32_32x32x32_bf16 v[0:15], v[60:63], v[40:47], v64
    s_mov_b64 exec, s[26:27]
    ds_read_b128 v[60:63], v68 offset:29408
    s_mov_b64 exec, -1
    v_exp_f32 v18, v18
    v_exp_f32 v19, v19
    v_exp_f32 v20, v20
    v_exp_f32 v21, v21
    s_waitcnt lgkmcnt(2)
    v_exp_f32 v22, v22
    v_mfma_f32_32x32x16_bf16 v[32:47], v[52:55], v[48:51], 0
    ds_read_b128 v[52:55], v66 offset:33024
    v_exp_f32 v23, v23
    v_exp_f32 v24, v24
    v_exp_f32 v25, v25
    v_exp_f32 v26, v26
    s_waitcnt lgkmcnt(2)
    v_exp_f32 v27, v27
    v_smfmac_f32_32x32x32_bf16 v[0:15], v[56:59], v[16:23], v64
    s_mov_b64 exec, s[26:27]
    ds_read_b128 v[56:59], v68 offset:30960
    s_mov_b64 exec, -1
    v_exp_f32 v28, v28
    v_exp_f32 v29, v29
    v_exp_f32 v30, v30
    v_exp_f32 v31, v31
    v_exp_f32 v32, v32
    s_waitcnt lgkmcnt(2)
    v_exp_f32 v33, v33
    v_smfmac_f32_32x32x32_bf16 v[0:15], v[60:63], v[24:31], v64
    s_mov_b64 exec, s[26:27]
    ds_read_b128 v[60:63], v68 offset:31472
    s_mov_b64 exec, -1
    v_exp_f32 v34, v34
    v_exp_f32 v35, v35
    v_exp_f32 v36, v36
    v_exp_f32 v37, v37
    s_waitcnt lgkmcnt(2)
    v_exp_f32 v38, v38
    v_mfma_f32_32x32x16_bf16 v[16:31], v[52:55], v[48:51], 0
    ds_read_b128 v[52:55], v66 offset:35088
    v_exp_f32 v39, v39
    v_exp_f32 v40, v40
    v_exp_f32 v41, v41
    v_exp_f32 v42, v42
    s_waitcnt lgkmcnt(2)
    v_exp_f32 v43, v43
    v_smfmac_f32_32x32x32_bf16 v[0:15], v[56:59], v[32:39], v64
    s_mov_b64 exec, s[26:27]
    ds_read_b128 v[56:59], v68 offset:33024
    s_mov_b64 exec, -1
    v_exp_f32 v44, v44
    v_exp_f32 v45, v45
    v_exp_f32 v46, v46
    v_exp_f32 v47, v47
    s_setprio 3
    v_exp_f32 v16, v16
    s_waitcnt lgkmcnt(2)
    v_exp_f32 v17, v17
    v_smfmac_f32_32x32x32_bf16 v[0:15], v[60:63], v[40:47], v64
    s_mov_b64 exec, s[26:27]
    ds_read_b128 v[60:63], v68 offset:33536
    s_mov_b64 exec, -1
    v_exp_f32 v18, v18
    v_exp_f32 v19, v19
    v_exp_f32 v20, v20
    v_exp_f32 v21, v21
    s_waitcnt lgkmcnt(2)
    v_exp_f32 v22, v22
    v_mfma_f32_32x32x16_bf16 v[32:47], v[52:55], v[48:51], 0
    ds_read_b128 v[52:55], v66 offset:37152
    v_exp_f32 v23, v23
    v_exp_f32 v24, v24
    s_bitcmp1_b32 s63, 2
    s_cbranch_scc0 fz_kernel_r17
    s_lshl2_add_u32 s96, s54, s77
    s_lshl_b32 s96, s96, 13
    s_add_u32 s96, s96, 0xc00100
    s_add_u32 s93, s96, 4096
    s_and_b32 s64, s58, 3
    s_lshl_b32 s64, s64, 6
    s_add_u32 s64, s64, s52
    s_lshl_b32 s64, s64, 10
    s_add_u32 s92, s64, 0xc00000
    buffer_load_dwordx4 v[96:99], v241, s[44:47], s96 offen offset:0 sc1
    buffer_load_dwordx4 v[100:103], v241, s[44:47], s96 offen offset:1024 sc1
    buffer_load_dwordx4 v[104:107], v241, s[44:47], s96 offen offset:2048 sc1
    buffer_load_dwordx4 v[108:111], v241, s[44:47], s96 offen offset:3072 sc1
    buffer_load_dwordx4 v[112:115], v241, s[44:47], s93 offen offset:0 sc1
    buffer_load_dwordx4 v[116:119], v241, s[44:47], s93 offen offset:1024 sc1
    buffer_load_dwordx4 v[120:123], v241, s[44:47], s93 offen offset:2048 sc1
    buffer_load_dwordx4 v[124:127], v241, s[44:47], s93 offen offset:3072 sc1
    buffer_load_dwordx2 v[76:77], v247, s[44:47], s92 offen sc1
fz_kernel_r17:
    v_exp_f32 v25, v25
    v_exp_f32 v26, v26
    s_waitcnt lgkmcnt(2)
    v_exp_f32 v27, v27
    v_smfmac_f32_32x32x32_bf16 v[0:15], v[56:59], v[16:23], v64
    s_mov_b64 exec, s[26:27]
    ds_read_b128 v[56:59], v68 offset:35088
    s_mov_b64 exec, -1
    v_exp_f32 v28, v28
    v_exp_f32 v29, v29
    v_exp_f32 v30, v30
    v_exp_f32 v31, v31
    v_exp_f32 v32, v32
    s_waitcnt lgkmcnt(2)
    v_exp_f32 v33, v33
    v_smfmac_f32_32x32x32_bf16 v[0:15], v[60:63], v[24:31], v64
    s_mov_b64 exec, s[26:27]
    ds_read_b128 v[60:63], v68 offset:35600
    s_mov_b64 exec, -1
    v_exp_f32 v34, v34
    v_exp_f32 v35, v35
    v_exp_f32 v36, v36
    v_exp_f32 v37, v37
    s_waitcnt lgkmcnt(2)
    v_exp_f32 v38, v38
    v_mfma_f32_32x32x16_bf16 v[16:31], v[52:55], v[48:51], 0
    ds_read_b128 v[52:55], v66 offset:39216
    v_exp_f32 v39, v39
    v_exp_f32 v40, v40
    v_exp_f32 v41, v41
    v_exp_f32 v42, v42
    s_waitcnt lgkmcnt(2)
    v_exp_f32 v43, v43
    v_smfmac_f32_32x32x32_bf16 v[0:15], v[56:59], v[32:39], v64
    s_mov_b64 exec, s[26:27]
    ds_read_b128 v[56:59], v68 offset:37152
    s_mov_b64 exec, -1
    v_exp_f32 v44, v44
    v_exp_f32 v45, v45
    v_exp_f32 v46, v46
    v_exp_f32 v47, v47
    v_exp_f32 v16, v16
    s_waitcnt lgkmcnt(2)
    v_exp_f32 v17, v17
    v_smfmac_f32_32x32x32_bf16 v[0:15], v[60:63], v[40:47], v64
    s_mov_b64 exec, s[26:27]
    ds_read_b128 v[60:63], v68 offset:37664
    s_mov_b64 exec, -1
    v_exp_f32 v18, v18
    v_exp_f32 v19, v19
    v_exp_f32 v20, v20
    v_exp_f32 v21, v21
    s_waitcnt lgkmcnt(2)
    v_exp_f32 v22, v22
    v_mfma_f32_32x32x16_bf16 v[32:47], v[52:55], v[48:51], 0
    ds_read_b128 v[52:55], v66 offset:41280
    v_exp_f32 v23, v23
    v_exp_f32 v24, v24
    v_exp_f32 v25, v25
    v_exp_f32 v26, v26
    s_waitcnt lgkmcnt(2)
    v_exp_f32 v27, v27
    v_smfmac_f32_32x32x32_bf16 v[0:15], v[56:59], v[16:23], v64
    s_mov_b64 exec, s[26:27]
    ds_read_b128 v[56:59], v68 offset:39216
    s_mov_b64 exec, -1
    v_exp_f32 v28, v28
    v_exp_f32 v29, v29
    v_exp_f32 v30, v30
    v_exp_f32 v31, v31
    v_exp_f32 v32, v32
    s_waitcnt lgkmcnt(2)
    v_exp_f32 v33, v33
    v_smfmac_f32_32x32x32_bf16 v[0:15], v[60:63], v[24:31], v64
    s_mov_b64 exec, s[26:27]
    ds_read_b128 v[60:63], v68 offset:39728
    s_mov_b64 exec, -1
    v_exp_f32 v34, v34
    v_exp_f32 v35, v35
    v_exp_f32 v36, v36
    v_exp_f32 v37, v37
    s_waitcnt lgkmcnt(2)
    v_exp_f32 v38, v38
    v_mfma_f32_32x32x16_bf16 v[16:31], v[52:55], v[48:51], 0
    ds_read_b128 v[52:55], v66 offset:43344
    v_exp_f32 v39, v39
    v_exp_f32 v40, v40
    s_add_u32 s64, s71, 0x9000
    buffer_load_dwordx4 v[208:211], v251, s[44:47], s64 offen
    v_exp_f32 v41, v41
    v_exp_f32 v42, v42
    s_waitcnt lgkmcnt(2)
    v_exp_f32 v43, v43
    v_smfmac_f32_32x32x32_bf16 v[0:15], v[56:59], v[32:39], v64
    s_mov_b64 exec, s[26:27]
    ds_read_b128 v[56:59], v68 offset:41280
    s_mov_b64 exec, -1
    v_exp_f32 v44, v44
    v_exp_f32 v45, v45
    s_add_u32 s64, s71, 0x19000
    buffer_load_dwordx4 v[212:215], v251, s[44:47], s64 offen
    v_exp_f32 v46, v46
    v_exp_f32 v47, v47
    s_setprio 2
    v_exp_f32 v16, v16
    s_waitcnt lgkmcnt(2)
    v_exp_f32 v17, v17
    v_smfmac_f32_32x32x32_bf16 v[0:15], v[60:63], v[40:47], v64
    s_mov_b64 exec, s[26:27]
    ds_read_b128 v[60:63], v68 offset:41792
    s_mov_b64 exec, -1
    v_exp_f32 v18, v18
    v_exp_f32 v19, v19
    s_bitcmp1_b32 s63, 2
    s_cbranch_scc0 fz_kernel_r18
    s_waitcnt vmcnt(2)
    v_max3_u32 v72, v77, v96, v102
    v_max3_u32 v72, v72, v104, v110
    v_max3_u32 v72, v72, v112, v118
    v_max3_u32 v72, v72, v120, v126
    v_min3_u32 v73, v77, v96, v102
    v_min3_u32 v73, v73, v104, v110
    v_min3_u32 v73, v73, v112, v118
    v_min3_u32 v73, v73, v120, v126
    v_cmp_ne_u32 vcc, v249, v72
    v_cmp_ne_u32_e64 s[90:91], v249, v73
    s_or_b64 vcc, vcc, s[90:91]
    s_cbranch_vccnz fz_kernel_kss
fz_kernel_ksk:
fz_kernel_r18:
    v_exp_f32 v20, v20
    v_exp_f32 v21, v21
    s_waitcnt lgkmcnt(2)
    v_exp_f32 v22, v22
    v_mfma_f32_32x32x16_bf16 v[32:47], v[52:55], v[48:51], 0
    ds_read_b128 v[52:55], v66 offset:45408
    v_exp_f32 v23, v23
    v_exp_f32 v24, v24
    s_add_u32 s64, s71, 0x9400
    buffer_load_dwordx4 v[216:219], v251, s[44:47], s64 offen
    v_exp_f32 v25, v25
    v_exp_f32 v26, v26
    s_waitcnt lgkmcnt(2)
    v_exp_f32 v27, v27
    v_smfmac_f32_32x32x32_bf16 v[0:15], v[56:59], v[16:23], v64
    s_mov_b64 exec, s[26:27]
    ds_read_b128 v[56:59], v68 offset:43344
    s_mov_b64 exec, -1
    v_exp_f32 v28, v28
    v_exp_f32 v29, v29
    s_add_u32 s64, s71, 0x19400
    buffer_load_dwordx4 v[220:223], v251, s[44:47], s64 offen
    v_exp_f32 v30, v30
    s_bitcmp1_b32 s63, 2
    s_cbranch_scc0 fz_kernel_r19
    v_mfma_f32_32x32x16_bf16 v[128:143], v[98:101], v[80:83], 0
    v_mfma_f32_32x32x16_bf16 v[128:143], v[106:109], v[84:87], v[128:143]
fz_kernel_r19:
    v_exp_f32 v31, v31
    v_exp_f32 v32, v32
    s_waitcnt lgkmcnt(2)
    v_exp_f32 v33, v33
    v_smfmac_f32_32x32x32_bf16 v[0:15], v[60:63], v[24:31], v64
    s_mov_b64 exec, s[26:27]
    ds_read_b128 v[60:63], v68 offset:43856
    s_mov_b64 exec, -1
    v_exp_f32 v34, v34
    v_exp_f32 v35, v35
    v_exp_f32 v36, v36
    v_exp_f32 v37, v37
    s_waitcnt lgkmcnt(2)
    v_exp_f32 v38, v38
    v_mfma_f32_32x32x16_bf16 v[16:31], v[52:55], v[48:51], 0
    ds_read_b128 v[52:55], v66 offset:47472
    v_exp_f32 v39, v39
    v_exp_f32 v40, v40
    s_add_u32 s64, s71, 0x9800
    buffer_load_dwordx4 v[224:227], v251, s[44:47], s64 offen
    v_exp_f32 v41, v41
    v_exp_f32 v42, v42
    s_waitcnt lgkmcnt(2)
    v_exp_f32 v43, v43
    v_smfmac_f32_32x32x32_bf16 v[0:15], v[56:59], v[32:39], v64
    s_mov_b64 exec, s[26:27]
    ds_read_b128 v[56:59], v68 offset:45408
    s_mov_b64 exec, -1
    v_exp_f32 v44, v44
    v_exp_f32 v45, v45
    s_add_u32 s64, s71, 0x19800
    buffer_load_dwordx4 v[228:231], v251, s[44:47], s64 offen
    s_bitcmp1_b32 s63, 2
    s_cbranch_scc0 fz_kernel_r20
    v_add_f32 v72, 0x358637bd, v136
    v_rcp_f32 v72, v72
    v_sub_f32 v73, 1.0, v76
    s_lshl4_add_u32 s96, s58, s54
    s_lshl1_add_u32 s96, s96, s77
    s_lshl_b32 s96, s96, 11
    s_add_u32 s96, s96, 0xd08000
    v_mul_f32 v72, v72, v73
    v_pk_mul_f32 v[128:129], v[128:129], v[72:73] op_sel_hi:[1,0]
    v_pk_mul_f32 v[130:131], v[130:131], v[72:73] op_sel_hi:[1,0]
    v_pk_mul_f32 v[132:133], v[132:133], v[72:73] op_sel_hi:[1,0]
    v_pk_mul_f32 v[134:135], v[134:135], v[72:73] op_sel_hi:[1,0]
    v_cvt_pk_bf16_f32 v136, v128, v129
    v_cvt_pk_bf16_f32 v137, v130, v131
    v_cvt_pk_bf16_f32 v138, v132, v133
    v_cvt_pk_bf16_f32 v139, v134, v135
    buffer_store_dwordx4 v[136:139], v251, s[44:47], s96 offen sc1
fz_kernel_r20:
    v_exp_f32 v46, v46
    s_bitcmp1_b32 s63, 2
    s_cbranch_scc0 fz_kernel_r21
    v_mfma_f32_32x32x16_bf16 v[144:159], v[114:117], v[88:91], 0
    v_mfma_f32_32x32x16_bf16 v[144:159], v[122:125], v[92:95], v[144:159]
fz_kernel_r21:
    v_exp_f32 v47, v47
    v_exp_f32 v16, v16
    s_waitcnt lgkmcnt(2)
    v_exp_f32 v17, v17
    v_smfmac_f32_32x32x32_bf16 v[0:15], v[60:63], v[40:47], v64
    s_mov_b64 exec, s[26:27]
    ds_read_b128 v[60:63], v68 offset:45920
    s_mov_b64 exec, -1
    v_exp_f32 v18, v18
    v_exp_f32 v19, v19
    v_exp_f32 v20, v20
    v_exp_f32 v21, v21
    s_waitcnt lgkmcnt(2)
    v_exp_f32 v22, v22
    v_mfma_f32_32x32x16_bf16 v[32:47], v[52:55], v[48:51], 0
    ds_read_b128 v[52:55], v66 offset:49536
    v_exp_f32 v23, v23
    v_exp_f32 v24, v24
    s_add_u32 s64, s71, 0x9c00
    buffer_load_dwordx4 v[232:235], v251, s[44:47], s64 offen
    v_exp_f32 v25, v25
    v_exp_f32 v26, v26
    s_waitcnt lgkmcnt(2)
    v_exp_f32 v27, v27
    v_smfmac_f32_32x32x32_bf16 v[0:15], v[56:59], v[16:23], v64
    s_mov_b64 exec, s[26:27]
    ds_read_b128 v[56:59], v68 offset:47472
    s_mov_b64 exec, -1
    v_exp_f32 v28, v28
    v_exp_f32 v29, v29
    s_add_u32 s64, s71, 0x19c00
    buffer_load_dwordx4 v[236:239], v251, s[44:47], s64 offen
    s_bitcmp1_b32 s63, 2
    s_cbranch_scc0 fz_kernel_r22
    v_add_f32 v72, 0x358637bd, v152
    v_rcp_f32 v72, v72
    v_sub_f32 v73, 1.0, v76
    s_add_u32 s96, s96, 0x400
    v_mul_f32 v72, v72, v73
    v_pk_mul_f32 v[144:145], v[144:145], v[72:73] op_sel_hi:[1,0]
    v_pk_mul_f32 v[146:147], v[146:147], v[72:73] op_sel_hi:[1,0]
    v_pk_mul_f32 v[148:149], v[148:149], v[72:73] op_sel_hi:[1,0]
    v_pk_mul_f32 v[150:151], v[150:151], v[72:73] op_sel_hi:[1,0]
    v_cvt_pk_bf16_f32 v152, v144, v145
    v_cvt_pk_bf16_f32 v153, v146, v147
    v_cvt_pk_bf16_f32 v154, v148, v149
    v_cvt_pk_bf16_f32 v155, v150, v151
    buffer_store_dwordx4 v[152:155], v251, s[44:47], s96 offen sc1
fz_kernel_r22:
    v_exp_f32 v30, v30
    v_exp_f32 v31, v31
    v_exp_f32 v32, v32
    s_waitcnt lgkmcnt(2)
    v_exp_f32 v33, v33
    v_smfmac_f32_32x32x32_bf16 v[0:15], v[60:63], v[24:31], v64
    s_mov_b64 exec, s[26:27]
    ds_read_b128 v[60:63], v68 offset:47984
    s_mov_b64 exec, -1
    v_exp_f32 v34, v34
    v_exp_f32 v35, v35
    v_exp_f32 v36, v36
    v_exp_f32 v37, v37
    s_waitcnt lgkmcnt(2)
    v_exp_f32 v38, v38
    v_mfma_f32_32x32x16_bf16 v[16:31], v[52:55], v[48:51], 0
    ds_read_b128 v[52:55], v66 offset:51600
    v_exp_f32 v39, v39
    v_exp_f32 v40, v40
    v_exp_f32 v41, v41
    v_exp_f32 v42, v42
    s_waitcnt lgkmcnt(2)
    v_exp_f32 v43, v43
    v_smfmac_f32_32x32x32_bf16 v[0:15], v[56:59], v[32:39], v64
    s_mov_b64 exec, s[26:27]
    ds_read_b128 v[56:59], v68 offset:49536
    s_mov_b64 exec, -1
    v_exp_f32 v44, v44
    v_exp_f32 v45, v45
    v_exp_f32 v46, v46
    v_exp_f32 v47, v47
    s_setprio 1
    v_exp_f32 v16, v16
    s_waitcnt lgkmcnt(2)
    v_exp_f32 v17, v17
    v_smfmac_f32_32x32x32_bf16 v[0:15], v[60:63], v[40:47], v64
    s_mov_b64 exec, s[26:27]
    ds_read_b128 v[60:63], v68 offset:50048
    s_mov_b64 exec, -1
    v_exp_f32 v18, v18
    v_exp_f32 v19, v19
    s_and_b32 s96, s3, 3
    s_lshl_b32 s96, s96, 5
    s_add_u32 s96, s96, s62
    s_lshl_b32 s96, s96, 1
    s_add_u32 s96, s96, s78
    s_lshl_b32 s96, s96, 10
    s_add_u32 s96, s96, 0xc00000
    buffer_load_dwordx2 v[76:77], v247, s[44:47], s96 offen sc1
    v_exp_f32 v20, v20
    v_exp_f32 v21, v21
    s_waitcnt lgkmcnt(2)
    v_exp_f32 v22, v22
    v_mfma_f32_32x32x16_bf16 v[32:47], v[52:55], v[48:51], 0
    ds_read_b128 v[52:55], v66 offset:53664
    v_exp_f32 v23, v23
    v_exp_f32 v24, v24
    v_exp_f32 v25, v25
    v_exp_f32 v26, v26
    s_waitcnt lgkmcnt(2)
    v_exp_f32 v27, v27
    v_smfmac_f32_32x32x32_bf16 v[0:15], v[56:59], v[16:23], v64
    s_mov_b64 exec, s[26:27]
    ds_read_b128 v[56:59], v68 offset:51600
    s_mov_b64 exec, -1
    v_exp_f32 v28, v28
    v_exp_f32 v29, v29
    v_exp_f32 v30, v30
    v_exp_f32 v31, v31
    v_exp_f32 v32, v32
    s_waitcnt lgkmcnt(2)
    v_exp_f32 v33, v33
    v_smfmac_f32_32x32x32_bf16 v[0:15], v[60:63], v[24:31], v64
    s_mov_b64 exec, s[26:27]
    ds_read_b128 v[60:63], v68 offset:52112
    s_mov_b64 exec, -1
    v_exp_f32 v34, v34
    v_exp_f32 v35, v35
    v_exp_f32 v36, v36
    v_exp_f32 v37, v37
    s_waitcnt lgkmcnt(2)
    v_exp_f32 v38, v38
    v_mfma_f32_32x32x16_bf16 v[16:31], v[52:55], v[48:51], 0
    ds_read_b128 v[52:55], v66 offset:55728
    v_exp_f32 v39, v39
    v_exp_f32 v40, v40
    v_exp_f32 v41, v41
    v_exp_f32 v42, v42
    s_waitcnt lgkmcnt(2)
    v_exp_f32 v43, v43
    v_smfmac_f32_32x32x32_bf16 v[0:15], v[56:59], v[32:39], v64
    s_mov_b64 exec, s[26:27]
    ds_read_b128 v[56:59], v68 offset:53664
    s_mov_b64 exec, -1
    v_exp_f32 v44, v44
    v_exp_f32 v45, v45
    v_exp_f32 v46, v46
    v_exp_f32 v47, v47
    v_exp_f32 v16, v16
    s_waitcnt lgkmcnt(2)
    v_exp_f32 v17, v17
    v_smfmac_f32_32x32x32_bf16 v[0:15], v[60:63], v[40:47], v64
    s_mov_b64 exec, s[26:27]
    ds_read_b128 v[60:63], v68 offset:54176
    s_mov_b64 exec, -1
    v_exp_f32 v18, v18
    v_exp_f32 v19, v19
    ds_read_b32 v79, v242 offset:64
    s_bitcmp1_b32 s63, 2
    s_cbranch_scc0 fz_kernel_r23
    s_waitcnt vmcnt(1)
    s_mov_b64 exec, 1
    buffer_store_dword v249, off, s[44:47], s79 sc1
    s_mov_b64 exec, -1
fz_kernel_r23:
    v_exp_f32 v20, v20
    v_exp_f32 v21, v21
    s_waitcnt lgkmcnt(3)
    v_exp_f32 v22, v22
    v_mfma_f32_32x32x16_bf16 v[32:47], v[52:55], v[48:51], 0
    ds_read_b128 v[52:55], v66 offset:57792
    v_exp_f32 v23, v23
    v_exp_f32 v24, v24
    v_exp_f32 v25, v25
    v_exp_f32 v26, v26
    s_waitcnt lgkmcnt(3)
    v_exp_f32 v27, v27
    v_smfmac_f32_32x32x32_bf16 v[0:15], v[56:59], v[16:23], v64
    s_mov_b64 exec, s[26:27]
    ds_read_b128 v[56:59], v68 offset:55728
    s_mov_b64 exec, -1
    v_exp_f32 v28, v28
    v_exp_f32 v29, v29
    v_exp_f32 v30, v30
    v_exp_f32 v31, v31
    v_exp_f32 v32, v32
    s_waitcnt lgkmcnt(3)
    v_exp_f32 v33, v33
    v_smfmac_f32_32x32x32_bf16 v[0:15], v[60:63], v[24:31], v64
    s_mov_b64 exec, s[26:27]
    ds_read_b128 v[60:63], v68 offset:56240
    s_mov_b64 exec, -1
    v_exp_f32 v34, v34
    v_exp_f32 v35, v35
    s_waitcnt vmcnt(0)
    v_cmp_ne_u32 vcc, v249, v77
    s_cbranch_vccnz fz_kernel_gs
fz_kernel_gk:
    v_mov_b32 v71, v76
    v_exp_f32 v36, v36
    v_exp_f32 v37, v37
    s_waitcnt lgkmcnt(2)
    v_exp_f32 v38, v38
    v_mfma_f32_32x32x16_bf16 v[16:31], v[52:55], v[48:51], 0
    ds_read_b128 v[52:55], v66 offset:59856
    v_exp_f32 v39, v39
    v_exp_f32 v40, v40
    v_exp_f32 v41, v41
    v_exp_f32 v42, v42
    s_waitcnt lgkmcnt(2)
    v_exp_f32 v43, v43
    v_smfmac_f32_32x32x32_bf16 v[0:15], v[56:59], v[32:39], v64
    s_mov_b64 exec, s[26:27]
    ds_read_b128 v[56:59], v68 offset:57792
    s_mov_b64 exec, -1
    v_exp_f32 v44, v44
    v_exp_f32 v45, v45
    v_exp_f32 v46, v46
    v_exp_f32 v47, v47
    s_setprio 0
    v_exp_f32 v16, v16
    s_waitcnt lgkmcnt(2)
    v_exp_f32 v17, v17
    v_smfmac_f32_32x32x32_bf16 v[0:15], v[60:63], v[40:47], v64
    s_mov_b64 exec, s[26:27]
    ds_read_b128 v[60:63], v68 offset:58304
    s_mov_b64 exec, -1
    v_exp_f32 v18, v18
    v_exp_f32 v19, v19
    s_waitcnt lgkmcnt(6)
    v_cmp_ne_u32 vcc, 0xeeeeeee8, v79
    s_cbranch_vccnz fz_kernel_cn1s
fz_kernel_cn1k:
    v_exp_f32 v20, v20
    v_exp_f32 v21, v21
    s_waitcnt lgkmcnt(2)
    v_exp_f32 v22, v22
    v_mfma_f32_32x32x16_bf16 v[32:47], v[52:55], v[48:51], 0
    ds_read_b128 v[52:55], v66 offset:61920
    v_exp_f32 v23, v23
    v_exp_f32 v24, v24
    v_exp_f32 v25, v25
    v_exp_f32 v26, v26
    s_waitcnt lgkmcnt(2)
    v_exp_f32 v27, v27
    v_smfmac_f32_32x32x32_bf16 v[0:15], v[56:59], v[16:23], v64
    s_mov_b64 exec, s[26:27]
    ds_read_b128 v[56:59], v68 offset:59856
    s_mov_b64 exec, -1
    v_exp_f32 v28, v28
    v_exp_f32 v29, v29
    v_exp_f32 v30, v30
    v_exp_f32 v31, v31
    v_exp_f32 v32, v32
    s_waitcnt lgkmcnt(2)
    v_exp_f32 v33, v33
    v_smfmac_f32_32x32x32_bf16 v[0:15], v[60:63], v[24:31], v64
    s_mov_b64 exec, s[26:27]
    ds_read_b128 v[60:63], v68 offset:60368
    s_mov_b64 exec, -1
    v_exp_f32 v34, v34
    v_exp_f32 v35, v35
    v_exp_f32 v36, v36
    v_exp_f32 v37, v37
    s_waitcnt lgkmcnt(2)
    v_exp_f32 v38, v38
    v_mfma_f32_32x32x16_bf16 v[16:31], v[52:55], v[48:51], 0
    ds_read_b128 v[52:55], v66 offset:63984
    v_exp_f32 v39, v39
    v_exp_f32 v40, v40
    v_exp_f32 v41, v41
    v_exp_f32 v42, v42
    s_waitcnt lgkmcnt(2)
    v_exp_f32 v43, v43
    v_smfmac_f32_32x32x32_bf16 v[0:15], v[56:59], v[32:39], v64
    s_mov_b64 exec, s[26:27]
    ds_read_b128 v[56:59], v68 offset:61920
    s_mov_b64 exec, -1
    v_exp_f32 v44, v44
    v_exp_f32 v45, v45
    v_exp_f32 v46, v46
    v_exp_f32 v47, v47
    v_exp_f32 v16, v16
    s_waitcnt lgkmcnt(2)
    v_exp_f32 v17, v17
    v_smfmac_f32_32x32x32_bf16 v[0:15], v[60:63], v[40:47], v64
    s_mov_b64 exec, s[26:27]
    ds_read_b128 v[60:63], v68 offset:62432
    s_mov_b64 exec, -1
    v_exp_f32 v18, v18
    v_exp_f32 v19, v19
    v_exp_f32 v20, v20
    v_exp_f32 v21, v21
    s_waitcnt lgkmcnt(2)
    v_exp_f32 v22, v22
    v_mfma_f32_32x32x16_bf16 v[32:47], v[52:55], v[48:51], 0
    ds_read_b128 v[52:55], v65 offset:0
    v_exp_f32 v23, v23
    v_exp_f32 v24, v24
    v_exp_f32 v25, v25
    s_add_u32 s64, s71, 0x0
    buffer_load_dwordx4 v[80:83], v251, s[44:47], s64 offen
    v_exp_f32 v26, v26
    s_waitcnt lgkmcnt(2)
    v_exp_f32 v27, v27
    v_smfmac_f32_32x32x32_bf16 v[0:15], v[56:59], v[16:23], v64
    s_mov_b64 exec, s[26:27]
    ds_read_b128 v[56:59], v68 offset:63984
    s_mov_b64 exec, -1
    v_exp_f32 v28, v28
    v_exp_f32 v29, v29
    v_exp_f32 v30, v30
    s_add_u32 s64, s71, 0x10000
    buffer_load_dwordx4 v[84:87], v251, s[44:47], s64 offen
    v_exp_f32 v31, v31
    v_exp_f32 v32, v32
    s_waitcnt lgkmcnt(2)
    v_exp_f32 v33, v33
    v_smfmac_f32_32x32x32_bf16 v[0:15], v[60:63], v[24:31], v64
    s_mov_b64 exec, s[26:27]
    ds_read_b128 v[60:63], v68 offset:64496
    s_mov_b64 exec, -1
    v_exp_f32 v34, v34
    v_exp_f32 v35, v35
    v_exp_f32 v36, v36
    v_exp_f32 v37, v37
    s_waitcnt lgkmcnt(2)
    v_exp_f32 v38, v38
    v_mfma_f32_32x32x16_bf16 v[16:31], v[52:55], v[48:51], 0
    ds_read_b128 v[52:55], v65 offset:2064
    v_exp_f32 v39, v39
    v_exp_f32 v40, v40
    v_exp_f32 v41, v41
    s_add_u32 s64, s71, 0x400
    buffer_load_dwordx4 v[88:91], v251, s[44:47], s64 offen
    v_exp_f32 v42, v42
    s_waitcnt lgkmcnt(2)
    v_exp_f32 v43, v43
    v_smfmac_f32_32x32x32_bf16 v[0:15], v[56:59], v[32:39], v64
    s_mov_b64 exec, s[26:27]
    ds_read_b128 v[56:59], v67 offset:0
    s_mov_b64 exec, -1
    v_exp_f32 v44, v44
    v_exp_f32 v45, v45
    v_exp_f32 v46, v46
    s_add_u32 s64, s71, 0x10400
    buffer_load_dwordx4 v[92:95], v251, s[44:47], s64 offen
    v_exp_f32 v47, v47
    s_setprio 3
    v_exp_f32 v16, v16
    s_waitcnt lgkmcnt(2)
    v_exp_f32 v17, v17
    v_smfmac_f32_32x32x32_bf16 v[0:15], v[60:63], v[40:47], v64
    s_mov_b64 exec, s[26:27]
    ds_read_b128 v[60:63], v67 offset:512
    s_mov_b64 exec, -1
    v_exp_f32 v18, v18
    v_exp_f32 v19, v19
    v_exp_f32 v20, v20
    v_exp_f32 v21, v21
    s_waitcnt lgkmcnt(2)
    v_exp_f32 v22, v22
    v_mfma_f32_32x32x16_bf16 v[32:47], v[52:55], v[48:51], 0
    ds_read_b128 v[52:55], v65 offset:4128
    v_exp_f32 v23, v23
    v_exp_f32 v24, v24
    v_exp_f32 v25, v25
    s_add_u32 s64, s71, 0x800
    buffer_load_dwordx4 v[128:131], v251, s[44:47], s64 offen
    v_exp_f32 v26, v26
    s_waitcnt lgkmcnt(2)
    v_exp_f32 v27, v27
    v_smfmac_f32_32x32x32_bf16 v[0:15], v[56:59], v[16:23], v64
    s_mov_b64 exec, s[26:27]
    ds_read_b128 v[56:59], v67 offset:2064
    s_mov_b64 exec, -1
    v_exp_f32 v28, v28
    v_exp_f32 v29, v29
    v_exp_f32 v30, v30
    s_add_u32 s64, s71, 0x10800
    buffer_load_dwordx4 v[132:135], v251, s[44:47], s64 offen
    v_exp_f32 v31, v31
    v_exp_f32 v32, v32
    s_waitcnt lgkmcnt(2)
    v_exp_f32 v33, v33
    v_smfmac_f32_32x32x32_bf16 v[0:15], v[60:63], v[24:31], v64
    s_mov_b64 exec, s[26:27]
    ds_read_b128 v[60:63], v67 offset:2576
    s_mov_b64 exec, -1
    v_exp_f32 v34, v34
    v_exp_f32 v35, v35
    v_exp_f32 v36, v36
    v_exp_f32 v37, v37
    s_waitcnt lgkmcnt(2)
    v_exp_f32 v38, v38
    v_mfma_f32_32x32x16_bf16 v[16:31], v[52:55], v[48:51], 0
    ds_read_b128 v[52:55], v65 offset:6192
    v_exp_f32 v39, v39
    v_exp_f32 v40, v40
    v_exp_f32 v41, v41
    s_add_u32 s64, s71, 0xc00
    buffer_load_dwordx4 v[136:139], v251, s[44:47], s64 offen
    v_exp_f32 v42, v42
    s_waitcnt lgkmcnt(2)
    v_exp_f32 v43, v43
    v_smfmac_f32_32x32x32_bf16 v[0:15], v[56:59], v[32:39], v64
    s_mov_b64 exec, s[26:27]
    ds_read_b128 v[56:59], v67 offset:4128
    s_mov_b64 exec, -1
    v_exp_f32 v44, v44
    v_exp_f32 v45, v45
    v_exp_f32 v46, v46
    s_add_u32 s64, s71, 0x10c00
    buffer_load_dwordx4 v[140:143], v251, s[44:47], s64 offen
    v_exp_f32 v47, v47
    v_exp_f32 v16, v16
    s_waitcnt lgkmcnt(2)
    v_exp_f32 v17, v17
    v_smfmac_f32_32x32x32_bf16 v[0:15], v[60:63], v[40:47], v64
    s_mov_b64 exec, s[26:27]
    ds_read_b128 v[60:63], v67 offset:4640
    s_mov_b64 exec, -1
    v_exp_f32 v18, v18
    v_exp_f32 v19, v19
    v_exp_f32 v20, v20
    v_exp_f32 v21, v21
    s_waitcnt lgkmcnt(2)
    v_exp_f32 v22, v22
    v_mfma_f32_32x32x16_bf16 v[32:47], v[52:55], v[48:51], 0
    ds_read_b128 v[52:55], v65 offset:8256
    v_exp_f32 v23, v23
    v_exp_f32 v24, v24
    v_exp_f32 v25, v25
    s_add_u32 s64, s71, 0x1000
    buffer_load_dwordx4 v[144:147], v251, s[44:47], s64 offen
    v_exp_f32 v26, v26
    s_waitcnt lgkmcnt(2)
    v_exp_f32 v27, v27
    v_smfmac_f32_32x32x32_bf16 v[0:15], v[56:59], v[16:23], v64
    s_mov_b64 exec, s[26:27]
    ds_read_b128 v[56:59], v67 offset:6192
    s_mov_b64 exec, -1
    v_exp_f32 v28, v28
    v_exp_f32 v29, v29
    v_exp_f32 v30, v30
    s_add_u32 s64, s71, 0x11000
    buffer_load_dwordx4 v[148:151], v251, s[44:47], s64 offen
    v_exp_f32 v31, v31
    v_exp_f32 v32, v32
    s_waitcnt lgkmcnt(2)
    v_exp_f32 v33, v33
    v_smfmac_f32_32x32x32_bf16 v[0:15], v[60:63], v[24:31], v64
    s_mov_b64 exec, s[26:27]
    ds_read_b128 v[60:63], v67 offset:6704
    s_mov_b64 exec, -1
    v_exp_f32 v34, v34
    v_exp_f32 v35, v35
    v_exp_f32 v36, v36
    v_exp_f32 v37, v37
    s_waitcnt lgkmcnt(2)
    v_exp_f32 v38, v38
    v_mfma_f32_32x32x16_bf16 v[16:31], v[52:55], v[48:51], 0
    ds_read_b128 v[52:55], v65 offset:10320
    v_exp_f32 v39, v39
    v_exp_f32 v40, v40
    v_exp_f32 v41, v41
    s_add_u32 s64, s71, 0x1400
    buffer_load_dwordx4 v[152:155], v251, s[44:47], s64 offen
    v_exp_f32 v42, v42
    s_waitcnt lgkmcnt(2)
    v_exp_f32 v43, v43
    v_smfmac_f32_32x32x32_bf16 v[0:15], v[56:59], v[32:39], v64
    s_mov_b64 exec, s[26:27]
    ds_read_b128 v[56:59], v67 offset:8256
    s_mov_b64 exec, -1
    v_exp_f32 v44, v44
    v_exp_f32 v45, v45
    v_exp_f32 v46, v46
    s_add_u32 s64, s71, 0x11400
    buffer_load_dwordx4 v[156:159], v251, s[44:47], s64 offen
    v_exp_f32 v47, v47
    v_exp_f32 v16, v16
    s_waitcnt lgkmcnt(2)
    v_exp_f32 v17, v17
    v_smfmac_f32_32x32x32_bf16 v[0:15], v[60:63], v[40:47], v64
    s_mov_b64 exec, s[26:27]
    ds_read_b128 v[60:63], v67 offset:8768
    s_mov_b64 exec, -1
    v_exp_f32 v18, v18
    v_exp_f32 v19, v19
    v_exp_f32 v20, v20
    v_exp_f32 v21, v21
    s_waitcnt lgkmcnt(2)
    v_exp_f32 v22, v22
    v_mfma_f32_32x32x16_bf16 v[32:47], v[52:55], v[48:51], 0
    ds_read_b128 v[52:55], v65 offset:12384
    v_exp_f32 v23, v23
    v_exp_f32 v24, v24
    v_exp_f32 v25, v25
    s_add_u32 s64, s71, 0x1800
    buffer_load_dwordx4 v[160:163], v251, s[44:47], s64 offen
    v_exp_f32 v26, v26
    s_waitcnt lgkmcnt(2)
    v_exp_f32 v27, v27
    v_smfmac_f32_32x32x32_bf16 v[0:15], v[56:59], v[16:23], v64
    s_mov_b64 exec, s[26:27]
    ds_read_b128 v[56:59], v67 offset:10320
    s_mov_b64 exec, -1
    v_exp_f32 v28, v28
    v_exp_f32 v29, v29
    v_exp_f32 v30, v30
    s_add_u32 s64, s71, 0x11800
    buffer_load_dwordx4 v[164:167], v251, s[44:47], s64 offen
    v_exp_f32 v31, v31
    v_exp_f32 v32, v32
    s_waitcnt lgkmcnt(2)
    v_exp_f32 v33, v33
    v_smfmac_f32_32x32x32_bf16 v[0:15], v[60:63], v[24:31], v64
    s_mov_b64 exec, s[26:27]
    ds_read_b128 v[60:63], v67 offset:10832
    s_mov_b64 exec, -1
    v_exp_f32 v34, v34
    v_exp_f32 v35, v35
    v_exp_f32 v36, v36
    v_exp_f32 v37, v37
    s_waitcnt lgkmcnt(2)
    v_exp_f32 v38, v38
    v_mfma_f32_32x32x16_bf16 v[16:31], v[52:55], v[48:51], 0
    ds_read_b128 v[52:55], v65 offset:14448
    v_exp_f32 v39, v39
    v_exp_f32 v40, v40
    v_exp_f32 v41, v41
    s_add_u32 s64, s71, 0x1c00
    buffer_load_dwordx4 v[168:171], v251, s[44:47], s64 offen
    v_exp_f32 v42, v42
    s_waitcnt lgkmcnt(2)
    v_exp_f32 v43, v43
    v_smfmac_f32_32x32x32_bf16 v[0:15], v[56:59], v[32:39], v64
    s_mov_b64 exec, s[26:27]
    ds_read_b128 v[56:59], v67 offset:12384
    s_mov_b64 exec, -1
    v_exp_f32 v44, v44
    v_exp_f32 v45, v45
    v_exp_f32 v46, v46
    s_add_u32 s64, s71, 0x11c00
    buffer_load_dwordx4 v[172:175], v251, s[44:47], s64 offen
    v_exp_f32 v47, v47
    v_exp_f32 v16, v16
    s_waitcnt lgkmcnt(2)
    v_exp_f32 v17, v17
    v_smfmac_f32_32x32x32_bf16 v[0:15], v[60:63], v[40:47], v64
    s_mov_b64 exec, s[26:27]
    ds_read_b128 v[60:63], v67 offset:12896
    s_mov_b64 exec, -1
    v_exp_f32 v18, v18
    v_exp_f32 v19, v19
    s_lshl2_add_u32 s64, s62, s76
    s_mul_i32 s64, s64, 8192
    s_and_b32 s65, s2, 7
    s_mul_i32 s65, s65, 128
    s_add_u32 s64, s64, s65
    s_add_u32 s64, s64, 0x1140000
    v_and_b32 v72, 7, v250
    v_lshl_add_u32 v245, v72, 10, s64
    s_bfe_u32 s65, s2, 0x10002
    s_lshl1_add_u32 s64, s62, s65
    s_lshl_b32 s65, s76, 8
    s_lshl2_add_u32 s64, s64, s65
    s_and_b32 s65, s2, 3
    s_lshl1_add_u32 s64, s64, s65
    s_lshl_b32 s64, s64, 7
    s_add_u32 s64, s64, 0x1104200
    s_mov_b64 vcc, 0xff
    v_and_b32 v72, 1, v250
    v_and_b32 v73, 2, v250
    v_lshl_add_u32 v72, v72, 15, s64
    v_lshl_add_u32 v72, v73, 5, v72
    v_cndmask_b32 v243, v72, v245, vcc
    buffer_load_dword v240, v243, s[44:47], 0 offen sc1
    v_exp_f32 v20, v20
    v_exp_f32 v21, v21
    s_waitcnt lgkmcnt(2)
    v_exp_f32 v22, v22
    v_mfma_f32_32x32x16_bf16 v[32:47], v[52:55], v[48:51], 0
    ds_read_b128 v[52:55], v65 offset:16512
    v_exp_f32 v23, v23
    v_exp_f32 v24, v24
    v_exp_f32 v25, v25
    v_exp_f32 v26, v26
    s_waitcnt lgkmcnt(2)
    v_exp_f32 v27, v27
    v_smfmac_f32_32x32x32_bf16 v[0:15], v[56:59], v[16:23], v64
    s_mov_b64 exec, s[26:27]
    ds_read_b128 v[56:59], v67 offset:14448
    s_mov_b64 exec, -1
    v_exp_f32 v28, v28
    v_exp_f32 v29, v29
    v_exp_f32 v30, v30
    v_exp_f32 v31, v31
    v_exp_f32 v32, v32
    s_waitcnt lgkmcnt(2)
    v_exp_f32 v33, v33
    v_smfmac_f32_32x32x32_bf16 v[0:15], v[60:63], v[24:31], v64
    s_mov_b64 exec, s[26:27]
    ds_read_b128 v[60:63], v67 offset:14960
    s_mov_b64 exec, -1
    v_exp_f32 v34, v34
    v_exp_f32 v35, v35
    v_exp_f32 v36, v36
    v_exp_f32 v37, v37
    s_waitcnt lgkmcnt(2)
    v_exp_f32 v38, v38
    v_mfma_f32_32x32x16_bf16 v[16:31], v[52:55], v[48:51], 0
    ds_read_b128 v[52:55], v65 offset:18576
    v_exp_f32 v39, v39
    v_exp_f32 v40, v40
    v_exp_f32 v41, v41
    v_exp_f32 v42, v42
    s_waitcnt lgkmcnt(2)
    v_exp_f32 v43, v43
    v_smfmac_f32_32x32x32_bf16 v[0:15], v[56:59], v[32:39], v64
    s_mov_b64 exec, s[26:27]
    ds_read_b128 v[56:59], v67 offset:16512
    s_mov_b64 exec, -1
    v_exp_f32 v44, v44
    v_exp_f32 v45, v45
    v_exp_f32 v46, v46
    v_exp_f32 v47, v47
    s_setprio 2
    v_exp_f32 v16, v16
    s_waitcnt lgkmcnt(2)
    v_exp_f32 v17, v17
    v_smfmac_f32_32x32x32_bf16 v[0:15], v[60:63], v[40:47], v64
    s_mov_b64 exec, s[26:27]
    ds_read_b128 v[60:63], v67 offset:17024
    s_mov_b64 exec, -1
    v_exp_f32 v18, v18
    v_exp_f32 v19, v19
    v_exp_f32 v20, v20
    v_exp_f32 v21, v21
    s_waitcnt lgkmcnt(2)
    v_exp_f32 v22, v22
    v_mfma_f32_32x32x16_bf16 v[32:47], v[52:55], v[48:51], 0
    ds_read_b128 v[52:55], v65 offset:20640
    v_exp_f32 v23, v23
    v_exp_f32 v24, v24
    v_exp_f32 v25, v25
    v_exp_f32 v26, v26
    s_waitcnt lgkmcnt(2)
    v_exp_f32 v27, v27
    v_smfmac_f32_32x32x32_bf16 v[0:15], v[56:59], v[16:23], v64
    s_mov_b64 exec, s[26:27]
    ds_read_b128 v[56:59], v67 offset:18576
    s_mov_b64 exec, -1
    v_exp_f32 v28, v28
    v_exp_f32 v29, v29
    v_exp_f32 v30, v30
    v_exp_f32 v31, v31
    v_exp_f32 v32, v32
    s_waitcnt lgkmcnt(2)
    v_exp_f32 v33, v33
    v_smfmac_f32_32x32x32_bf16 v[0:15], v[60:63], v[24:31], v64
    s_mov_b64 exec, s[26:27]
    ds_read_b128 v[60:63], v67 offset:19088
    s_mov_b64 exec, -1
    v_exp_f32 v34, v34
    s_waitcnt vmcnt(0)
    v_xor_b32 v72, v249, v240
    v_cmp_lt_u32 vcc, 1, v72
    s_cbranch_vccnz fz_kernel_f2s
fz_kernel_f2k:
    v_exp_f32 v35, v35
    s_add_u32 s64, s72, 0x8000
    buffer_load_dwordx4 v[96:99], v251, s[44:47], s64 offen
    v_exp_f32 v36, v36
    v_exp_f32 v37, v37
    s_waitcnt lgkmcnt(2)
    v_exp_f32 v38, v38
    v_mfma_f32_32x32x16_bf16 v[16:31], v[52:55], v[48:51], 0
    ds_read_b128 v[52:55], v65 offset:22704
    v_exp_f32 v39, v39
    v_exp_f32 v40, v40
    s_add_u32 s64, s72, 0x8400
    buffer_load_dwordx4 v[100:103], v251, s[44:47], s64 offen
    v_exp_f32 v41, v41
    v_exp_f32 v42, v42
    s_waitcnt lgkmcnt(2)
    v_exp_f32 v43, v43
    v_smfmac_f32_32x32x32_bf16 v[0:15], v[56:59], v[32:39], v64
    s_mov_b64 exec, s[26:27]
    ds_read_b128 v[56:59], v67 offset:20640
    s_mov_b64 exec, -1
    v_exp_f32 v44, v44
    v_exp_f32 v45, v45
    s_add_u32 s64, s72, 0x8800
    buffer_load_dwordx4 v[104:107], v251, s[44:47], s64 offen
    v_exp_f32 v46, v46
    v_exp_f32 v47, v47
    v_exp_f32 v16, v16
    s_waitcnt lgkmcnt(2)
    v_exp_f32 v17, v17
    v_smfmac_f32_32x32x32_bf16 v[0:15], v[60:63], v[40:47], v64
    s_mov_b64 exec, s[26:27]
    ds_read_b128 v[60:63], v67 offset:21152
    s_mov_b64 exec, -1
    v_exp_f32 v18, v18
    s_mov_b32 s73, 0xff
    s_mov_b32 s94, 0
    v_add_u32 v249, 1, v249
    s_add_u32 s93, s72, 4096
    v_exp_f32 v19, v19
    s_add_u32 s64, s72, 0x8c00
    buffer_load_dwordx4 v[108:111], v251, s[44:47], s64 offen
    v_exp_f32 v20, v20
    v_exp_f32 v21, v21
    s_waitcnt lgkmcnt(2)
    v_exp_f32 v22, v22
    v_mfma_f32_32x32x16_bf16 v[32:47], v[52:55], v[48:51], 0
    ds_read_b128 v[52:55], v65 offset:24768
    v_exp_f32 v23, v23
    v_exp_f32 v24, v24
    s_add_u32 s64, s72, 0x9000
    buffer_load_dwordx4 v[112:115], v251, s[44:47], s64 offen
    v_exp_f32 v25, v25
    v_exp_f32 v26, v26
    s_waitcnt lgkmcnt(2)
    v_exp_f32 v27, v27
    v_smfmac_f32_32x32x32_bf16 v[0:15], v[56:59], v[16:23], v64
    s_mov_b64 exec, s[26:27]
    ds_read_b128 v[56:59], v67 offset:22704
    s_mov_b64 exec, -1
    v_exp_f32 v28, v28
    v_exp_f32 v29, v29
    s_add_u32 s64, s72, 0x9400
    buffer_load_dwordx4 v[116:119], v251, s[44:47], s64 offen
    v_exp_f32 v30, v30
    v_exp_f32 v31, v31
    v_exp_f32 v32, v32
    s_waitcnt lgkmcnt(2)
    v_exp_f32 v33, v33
    v_smfmac_f32_32x32x32_bf16 v[0:15], v[60:63], v[24:31], v64
    s_mov_b64 exec, s[26:27]
    ds_read_b128 v[60:63], v67 offset:23216
    s_mov_b64 exec, -1
    v_exp_f32 v34, v34
    v_exp_f32 v35, v35
    s_add_u32 s64, s72, 0x9800
    buffer_load_dwordx4 v[120:123], v251, s[44:47], s64 offen
    v_exp_f32 v36, v36
    v_exp_f32 v37, v37
    s_waitcnt lgkmcnt(2)
    v_exp_f32 v38, v38
    v_mfma_f32_32x32x16_bf16 v[16:31], v[52:55], v[48:51], 0
    ds_read_b128 v[52:55], v65 offset:26832
    v_exp_f32 v39, v39
    v_exp_f32 v40, v40
    s_add_u32 s64, s72, 0x9c00
    buffer_load_dwordx4 v[124:127], v251, s[44:47], s64 offen
    v_exp_f32 v41, v41
    v_exp_f32 v42, v42
    s_waitcnt lgkmcnt(2)
    v_exp_f32 v43, v43
    v_smfmac_f32_32x32x32_bf16 v[0:15], v[56:59], v[32:39], v64
    s_mov_b64 exec, s[26:27]
    ds_read_b128 v[56:59], v67 offset:24768
    s_mov_b64 exec, -1
    v_exp_f32 v44, v44
    v_exp_f32 v45, v45
    v_exp_f32 v46, v46
    v_exp_f32 v47, v47
    s_setprio 1
    v_exp_f32 v16, v16
    s_waitcnt lgkmcnt(2)
    v_exp_f32 v17, v17
    v_smfmac_f32_32x32x32_bf16 v[0:15], v[60:63], v[40:47], v64
    s_mov_b64 exec, s[26:27]
    ds_read_b128 v[60:63], v67 offset:25280
    s_mov_b64 exec, -1
    v_exp_f32 v18, v18
    v_exp_f32 v19, v19
    v_exp_f32 v20, v20
    v_exp_f32 v21, v21
    s_waitcnt lgkmcnt(2)
    v_exp_f32 v22, v22
    v_mfma_f32_32x32x16_bf16 v[32:47], v[52:55], v[48:51], 0
    ds_read_b128 v[52:55], v65 offset:28896
    v_exp_f32 v23, v23
    v_exp_f32 v24, v24
    v_exp_f32 v25, v25
    v_exp_f32 v26, v26
    s_waitcnt lgkmcnt(2)
    v_exp_f32 v27, v27
    v_smfmac_f32_32x32x32_bf16 v[0:15], v[56:59], v[16:23], v64
    s_mov_b64 exec, s[26:27]
    ds_read_b128 v[56:59], v67 offset:26832
    s_mov_b64 exec, -1
    v_exp_f32 v28, v28
    v_exp_f32 v29, v29
    v_exp_f32 v30, v30
    v_exp_f32 v31, v31
    v_exp_f32 v32, v32
    s_waitcnt lgkmcnt(2)
    v_exp_f32 v33, v33
    v_smfmac_f32_32x32x32_bf16 v[0:15], v[60:63], v[24:31], v64
    s_mov_b64 exec, s[26:27]
    ds_read_b128 v[60:63], v67 offset:27344
    s_mov_b64 exec, -1
    v_exp_f32 v34, v34
    v_exp_f32 v35, v35
    v_exp_f32 v36, v36
    v_exp_f32 v37, v37
    s_waitcnt lgkmcnt(2)
    v_exp_f32 v38, v38
    v_mfma_f32_32x32x16_bf16 v[16:31], v[52:55], v[48:51], 0
    ds_read_b128 v[52:55], v65 offset:30960
    v_exp_f32 v39, v39
    v_exp_f32 v40, v40
    v_exp_f32 v41, v41
    v_exp_f32 v42, v42
    s_waitcnt lgkmcnt(2)
    v_exp_f32 v43, v43
    v_smfmac_f32_32x32x32_bf16 v[0:15], v[56:59], v[32:39], v64
    s_mov_b64 exec, s[26:27]
    ds_read_b128 v[56:59], v67 offset:28896
    s_mov_b64 exec, -1
    v_exp_f32 v44, v44
    v_exp_f32 v45, v45
    v_exp_f32 v46, v46
    v_exp_f32 v47, v47
    s_setprio 0
    v_exp_f32 v16, v16
    s_waitcnt lgkmcnt(2)
    v_exp_f32 v17, v17
    v_smfmac_f32_32x32x32_bf16 v[0:15], v[60:63], v[40:47], v64
    s_mov_b64 exec, s[26:27]
    ds_read_b128 v[60:63], v67 offset:29408
    s_mov_b64 exec, -1
    v_exp_f32 v18, v18
    v_exp_f32 v19, v19
    buffer_load_dword v240, v245, s[44:47], 0 offen sc1
    v_exp_f32 v20, v20
    v_exp_f32 v21, v21
    s_waitcnt lgkmcnt(2)
    v_exp_f32 v22, v22
    v_mfma_f32_32x32x16_bf16 v[32:47], v[52:55], v[48:51], 0
    v_exp_f32 v23, v23
    v_exp_f32 v24, v24
    v_exp_f32 v25, v25
    v_exp_f32 v26, v26
    s_waitcnt lgkmcnt(1)
    v_exp_f32 v27, v27
    v_smfmac_f32_32x32x32_bf16 v[0:15], v[56:59], v[16:23], v64
    s_mov_b64 exec, s[26:27]
    ds_read_b128 v[56:59], v67 offset:30960
    s_mov_b64 exec, -1
    v_exp_f32 v28, v28
    v_exp_f32 v29, v29
    v_exp_f32 v30, v30
    v_exp_f32 v31, v31
    v_exp_f32 v32, v32
    s_waitcnt lgkmcnt(1)
    v_exp_f32 v33, v33
    v_smfmac_f32_32x32x32_bf16 v[0:15], v[60:63], v[24:31], v64
    s_mov_b64 exec, s[26:27]
    ds_read_b128 v[60:63], v67 offset:31472
    s_mov_b64 exec, -1
    v_exp_f32 v34, v34
    v_exp_f32 v35, v35
    v_exp_f32 v36, v36
    v_exp_f32 v37, v37
    v_exp_f32 v38, v38
    v_exp_f32 v39, v39
    v_exp_f32 v40, v40
    v_exp_f32 v41, v41
    v_exp_f32 v42, v42
    s_waitcnt lgkmcnt(1)
    v_exp_f32 v43, v43
    v_smfmac_f32_32x32x32_bf16 v[0:15], v[56:59], v[32:39], v64
    v_exp_f32 v44, v44
    v_exp_f32 v45, v45
    v_exp_f32 v46, v46
    v_exp_f32 v47, v47
    s_waitcnt lgkmcnt(0)
    s_nop 0
    v_smfmac_f32_32x32x32_bf16 v[0:15], v[60:63], v[40:47], v64
    v_and_b32 v244, 31, v250
    v_mul_u32_u24 v244, 528, v244
    v_lshrrev_b32 v241, 5, v250
    v_lshl_add_u32 v244, v241, 4, v244
    s_mul_i32 s64, s76, 16896
    s_lshl_b32 s65, s77, 8
    s_add_u32 s64, s64, s65
    s_add_u32 s64, s64, 32768
    v_add_u32 v244, s64, v244
    s_mov_b32 s97, 0x8000
    s_mov_b32 s28, s20
    s_mov_b32 s29, s21
    s_mov_b32 s30, 0x200000
    s_mov_b32 s31, 0x00020000
    v_add_f32_e64 v72, |v0|, |v1|
    v_min3_f32 v73, |v0|, |v1|, |v2|
    v_rcp_f32 v74, v8
    v_add_f32_e64 v72, v72, |v2|
    v_add_f32_e64 v72, v72, |v3|
    v_add_f32_e64 v72, v72, |v4|
    v_add_f32_e64 v72, v72, |v5|
    v_add_f32_e64 v72, v72, |v6|
    v_add_f32_e64 v72, v72, |v7|
    v_min3_f32 v73, v73, |v3|, |v4|
    v_min3_f32 v73, v73, |v5|, |v6|
    v_min_f32_e64 v73, v73, |v7|
    v_cmp_le_f32 vcc, 0x21800000, v8
    s_mov_b64 s[90:91], vcc
    v_cmp_ge_f32 vcc, 0x71800000, v8
    s_and_b64 s[90:91], s[90:91], vcc
    v_cmp_ge_f32 vcc, 0x7b800000, v72
    s_and_b64 s[90:91], s[90:91], vcc
    v_cmp_le_f32 vcc, 0xd800000, v73
    s_and_b64 s[90:91], s[90:91], vcc
    s_cmp_eq_u64 s[90:91], -1
    s_cbranch_scc0 fz_kernel_slow
fz_kernel_fin:
    v_mul_f32 v72, v74, v71
    v_pk_mul_f32 v[0:1], v[0:1], v[72:73] op_sel_hi:[1,0]
    v_pk_mul_f32 v[2:3], v[2:3], v[72:73] op_sel_hi:[1,0]
    v_pk_mul_f32 v[4:5], v[4:5], v[72:73] op_sel_hi:[1,0]
    v_pk_mul_f32 v[6:7], v[6:7], v[72:73] op_sel_hi:[1,0]
    v_cvt_pk_bf16_f32 v64, v0, v1
    v_cvt_pk_bf16_f32 v65, v2, v3
    v_cvt_pk_bf16_f32 v66, v4, v5
    v_cvt_pk_bf16_f32 v67, v6, v7
    buffer_store_dwordx4 v[64:67], v251, s[44:47], s59 offen sc1
    s_mov_b64 exec, 1
    buffer_store_dword v249, off, s[44:47], s60 sc1
    s_mov_b64 exec, -1
    v_lshrrev_b32 v241, 4, v250
    v_and_b32 v242, 15, v250
    v_lshlrev_b32 v242, 4, v242
    v_lshl_add_u32 v73, v241, 10, v242
    v_mul_u32_u24 v241, 528, v241
    v_lshl_add_u32 v241, v242, 1, v241
    s_mul_i32 s64, s3, 2112
    s_add_u32 s64, s64, 32768
    v_add_u32 v241, s64, v241
    s_and_b32 s64, s2, 7
    s_lshl_b32 s65, s62, 3
    s_add_u32 s64, s64, s65
    s_lshl_b32 s64, s64, 3
    s_add_u32 s64, s64, s3
    s_lshl_b32 s64, s64, 12
    s_lshl_b32 s65, s75, 8
    s_add_u32 s96, s64, s65
    s_waitcnt vmcnt(2)
    s_branch fz_kernel_p3a
fz_kernel_p3l:
    s_waitcnt vmcnt(0)
fz_kernel_p3a:
    v_cmp_eq_u32 vcc, v249, v240
    s_mov_b32 s95, s94
    s_and_b32 s94, vcc_lo, s73
    s_andn2_b32 s64, s73, s94
    s_bcnt1_i32_b32 s65, s64
    s_cmp_le_u32 s65, 2
    s_cselect_b32 s94, s73, s94
    s_cmp_eq_u32 s94, 0
    s_cbranch_scc1 fz_kernel_p3bm
    s_bitcmp1_b32 s94, 0
    s_cbranch_scc0 fz_kernel_m0
    buffer_load_dwordx4 v[0:3], v251, s[44:47], s72 offen offset:0 sc1
fz_kernel_m0:
    s_bitcmp1_b32 s94, 1
    s_cbranch_scc0 fz_kernel_m1
    buffer_load_dwordx4 v[4:7], v251, s[44:47], s72 offen offset:1024 sc1
fz_kernel_m1:
    s_bitcmp1_b32 s94, 2
    s_cbranch_scc0 fz_kernel_m2
    buffer_load_dwordx4 v[8:11], v251, s[44:47], s72 offen offset:2048 sc1
fz_kernel_m2:
    s_bitcmp1_b32 s94, 3
    s_cbranch_scc0 fz_kernel_m3
    buffer_load_dwordx4 v[12:15], v251, s[44:47], s72 offen offset:3072 sc1
fz_kernel_m3:
    s_bitcmp1_b32 s94, 4
    s_cbranch_scc0 fz_kernel_m4
    buffer_load_dwordx4 v[48:51], v251, s[44:47], s93 offen offset:0 sc1
fz_kernel_m4:
    s_bitcmp1_b32 s94, 5
    s_cbranch_scc0 fz_kernel_m5
    buffer_load_dwordx4 v[52:55], v251, s[44:47], s93 offen offset:1024 sc1
fz_kernel_m5:
    s_bitcmp1_b32 s94, 6
    s_cbranch_scc0 fz_kernel_m6
    buffer_load_dwordx4 v[56:59], v251, s[44:47], s93 offen offset:2048 sc1
fz_kernel_m6:
    s_bitcmp1_b32 s94, 7
    s_cbranch_scc0 fz_kernel_m7
    buffer_load_dwordx4 v[60:63], v251, s[44:47], s93 offen offset:3072 sc1
fz_kernel_m7:
fz_kernel_p3bm:
    s_andn2_b32 s73, s73, s94
    s_cbranch_scc0 fz_kernel_p3c
    buffer_load_dword v240, v245, s[44:47], 0 offen sc1
fz_kernel_p3c:
    s_cmp_eq_u32 s95, 0
    s_cbranch_scc1 fz_kernel_p3d
    s_bitcmp1_b32 s95, 0
    s_cbranch_scc0 fz_kernel_n0
    v_max3_u32 v72, v0, v1, v2
    v_max_u32 v72, v72, v3
    v_cmp_eq_u32 vcc, -1, v72
    s_cbranch_vccnz fz_kernel_y0
    v_mfma_f32_32x32x16_bf16 v[16:31], v[80:83], v[0:3], v[16:31]
    v_mfma_f32_32x32x16_bf16 v[32:47], v[84:87], v[0:3], v[32:47]
fz_kernel_n0:
    s_bitcmp1_b32 s95, 1
    s_cbranch_scc0 fz_kernel_n1
    v_max3_u32 v72, v4, v5, v6
    v_max_u32 v72, v72, v7
    v_cmp_eq_u32 vcc, -1, v72
    s_cbranch_vccnz fz_kernel_y1
    v_mfma_f32_32x32x16_bf16 v[16:31], v[88:91], v[4:7], v[16:31]
    v_mfma_f32_32x32x16_bf16 v[32:47], v[92:95], v[4:7], v[32:47]
fz_kernel_n1:
    s_bitcmp1_b32 s95, 2
    s_cbranch_scc0 fz_kernel_n2
    v_max3_u32 v72, v8, v9, v10
    v_max_u32 v72, v72, v11
    v_cmp_eq_u32 vcc, -1, v72
    s_cbranch_vccnz fz_kernel_y2
    v_mfma_f32_32x32x16_bf16 v[16:31], v[128:131], v[8:11], v[16:31]
    v_mfma_f32_32x32x16_bf16 v[32:47], v[132:135], v[8:11], v[32:47]
fz_kernel_n2:
    s_bitcmp1_b32 s95, 3
    s_cbranch_scc0 fz_kernel_n3
    v_max3_u32 v72, v12, v13, v14
    v_max_u32 v72, v72, v15
    v_cmp_eq_u32 vcc, -1, v72
    s_cbranch_vccnz fz_kernel_y3
    v_mfma_f32_32x32x16_bf16 v[16:31], v[136:139], v[12:15], v[16:31]
    v_mfma_f32_32x32x16_bf16 v[32:47], v[140:143], v[12:15], v[32:47]
fz_kernel_n3:
    s_bitcmp1_b32 s95, 4
    s_cbranch_scc0 fz_kernel_n4
    v_max3_u32 v72, v48, v49, v50
    v_max_u32 v72, v72, v51
    v_cmp_eq_u32 vcc, -1, v72
    s_cbranch_vccnz fz_kernel_y4
    v_mfma_f32_32x32x16_bf16 v[16:31], v[144:147], v[48:51], v[16:31]
    v_mfma_f32_32x32x16_bf16 v[32:47], v[148:151], v[48:51], v[32:47]
fz_kernel_n4:
    s_bitcmp1_b32 s95, 5
    s_cbranch_scc0 fz_kernel_n5
    v_max3_u32 v72, v52, v53, v54
    v_max_u32 v72, v72, v55
    v_cmp_eq_u32 vcc, -1, v72
    s_cbranch_vccnz fz_kernel_y5
    v_mfma_f32_32x32x16_bf16 v[16:31], v[152:155], v[52:55], v[16:31]
    v_mfma_f32_32x32x16_bf16 v[32:47], v[156:159], v[52:55], v[32:47]
fz_kernel_n5:
    s_bitcmp1_b32 s95, 6
    s_cbranch_scc0 fz_kernel_n6
    v_max3_u32 v72, v56, v57, v58
    v_max_u32 v72, v72, v59
    v_cmp_eq_u32 vcc, -1, v72
    s_cbranch_vccnz fz_kernel_y6
    v_mfma_f32_32x32x16_bf16 v[16:31], v[160:163], v[56:59], v[16:31]
    v_mfma_f32_32x32x16_bf16 v[32:47], v[164:167], v[56:59], v[32:47]
fz_kernel_n6:
    s_bitcmp1_b32 s95, 7
    s_cbranch_scc0 fz_kernel_n7
    v_max3_u32 v72, v60, v61, v62
    v_max_u32 v72, v72, v63
    v_cmp_eq_u32 vcc, -1, v72
    s_cbranch_vccnz fz_kernel_y7
    v_mfma_f32_32x32x16_bf16 v[16:31], v[168:171], v[60:63], v[16:31]
    v_mfma_f32_32x32x16_bf16 v[32:47], v[172:175], v[60:63], v[32:47]
fz_kernel_n7:
fz_kernel_p3d:
    s_cmp_lg_u32 s97, 0x8000
    s_cbranch_scc1 fz_kernel_p3e
    s_barrier
    v_mfma_f32_32x32x16_bf16 v[16:31], v[176:179], v[96:99], 0
    v_mfma_f32_32x32x16_bf16 v[32:47], v[180:183], v[96:99], 0
    v_mfma_f32_32x32x16_bf16 v[16:31], v[184:187], v[100:103], v[16:31]
    v_mfma_f32_32x32x16_bf16 v[32:47], v[188:191], v[100:103], v[32:47]
    v_mfma_f32_32x32x16_bf16 v[16:31], v[192:195], v[104:107], v[16:31]
    v_mfma_f32_32x32x16_bf16 v[32:47], v[196:199], v[104:107], v[32:47]
    v_mfma_f32_32x32x16_bf16 v[16:31], v[200:203], v[108:111], v[16:31]
    v_mfma_f32_32x32x16_bf16 v[32:47], v[204:207], v[108:111], v[32:47]
    v_mfma_f32_32x32x16_bf16 v[16:31], v[208:211], v[112:115], v[16:31]
    v_mfma_f32_32x32x16_bf16 v[32:47], v[212:215], v[112:115], v[32:47]
    v_mfma_f32_32x32x16_bf16 v[16:31], v[216:219], v[116:119], v[16:31]
    v_mfma_f32_32x32x16_bf16 v[32:47], v[220:223], v[116:119], v[32:47]
    v_mfma_f32_32x32x16_bf16 v[16:31], v[224:227], v[120:123], v[16:31]
    v_mfma_f32_32x32x16_bf16 v[32:47], v[228:231], v[120:123], v[32:47]
    v_mfma_f32_32x32x16_bf16 v[16:31], v[232:235], v[124:127], v[16:31]
    v_mfma_f32_32x32x16_bf16 v[32:47], v[236:239], v[124:127], v[32:47]
fz_kernel_p3e:
    s_sub_u32 s97, s97, 1
    s_cbranch_scc1 fz_kernel_p3x
    s_or_b32 s64, s73, s94
    s_cbranch_scc1 fz_kernel_p3l
fz_kernel_p3x:
    s_nop 5
    ds_write_b128 v244, v[16:19] offset:0
    ds_write_b128 v244, v[20:23] offset:32
    ds_write_b128 v244, v[24:27] offset:64
    ds_write_b128 v244, v[28:31] offset:96
    ds_write_b128 v244, v[32:35] offset:128
    ds_write_b128 v244, v[36:39] offset:160
    ds_write_b128 v244, v[40:43] offset:192
    ds_write_b128 v244, v[44:47] offset:224
    s_waitcnt lgkmcnt(0)
    s_barrier
    s_or_b32 s64, s2, s3
    ds_read_b128 v[176:179], v241 offset:0
    ds_read_b128 v[180:183], v241 offset:16
    ds_read_b128 v[184:187], v241 offset:16896
    ds_read_b128 v[188:191], v241 offset:16912
    ds_read_b128 v[192:195], v241 offset:33792
    ds_read_b128 v[196:199], v241 offset:33808
    ds_read_b128 v[200:203], v241 offset:50688
    ds_read_b128 v[204:207], v241 offset:50704
    s_cbranch_scc1 fz_kernel_ntg
    s_mov_b32 s64, 0x1180000
    buffer_store_dword v249, off, s[44:47], s64 sc1
fz_kernel_ntg:
    s_waitcnt lgkmcnt(4)
    v_pk_add_f32 v[176:177], v[176:177], v[184:185]
    v_pk_add_f32 v[178:179], v[178:179], v[186:187]
    v_pk_add_f32 v[180:181], v[180:181], v[188:189]
    v_pk_add_f32 v[182:183], v[182:183], v[190:191]
    s_waitcnt lgkmcnt(2)
    v_pk_add_f32 v[176:177], v[176:177], v[192:193]
    v_pk_add_f32 v[178:179], v[178:179], v[194:195]
    v_pk_add_f32 v[180:181], v[180:181], v[196:197]
    v_pk_add_f32 v[182:183], v[182:183], v[198:199]
    s_waitcnt lgkmcnt(0)
    v_pk_add_f32 v[176:177], v[176:177], v[200:201]
    v_pk_add_f32 v[178:179], v[178:179], v[202:203]
    v_pk_add_f32 v[180:181], v[180:181], v[204:205]
    v_pk_add_f32 v[182:183], v[182:183], v[206:207]
    v_cvt_pk_bf16_f32 v52, v176, v177
    v_cvt_pk_bf16_f32 v53, v178, v179
    v_cvt_pk_bf16_f32 v54, v180, v181
    v_cvt_pk_bf16_f32 v55, v182, v183
    buffer_store_dwordx4 v[52:55], v73, s[28:31], s96 offen sc1
fz_kernel_exit:
    s_endpgm
fz_kernel_far0:
    s_mov_b32 s64, 3
fz_kernel_fa0:
    v_bfe_u32 v247, v251, 2, 7
    buffer_load_dword v247, v247, s[44:47], s79 offen sc1
    s_sub_u32 s64, s64, 1
    s_waitcnt vmcnt(0)
    v_cmp_ne_u32 vcc, v254, v247
    s_cbranch_vccz fz_kernel_near0
    s_cbranch_scc0 fz_kernel_fa0
    buffer_wbl2 sc1
    s_waitcnt vmcnt(0)
    buffer_store_dword v249, v246, s[44:47], s76 offen sc1
    s_branch fz_kernel_fb0
fz_kernel_far1:
    s_mov_b32 s64, 3
fz_kernel_fa1:
    v_bfe_u32 v247, v251, 2, 7
    buffer_load_dword v247, v247, s[44:47], s79 offen sc1
    s_sub_u32 s64, s64, 1
    s_waitcnt vmcnt(0)
    v_cmp_ne_u32 vcc, v254, v247
    s_cbranch_vccz fz_kernel_near1
    s_cbranch_scc0 fz_kernel_fa1
    buffer_wbl2 sc1
    s_waitcnt vmcnt(0)
    buffer_store_dword v249, v246, s[44:47], s76 offen sc1
    s_branch fz_kernel_fb1
fz_kernel_sm:
    s_mov_b32 s66, 1.0
    v_max3_f32 v72, v16, v17, v18
    v_max3_f32 v73, -v16, -v17, -v18
    v_max3_f32 v72, v72, v19, v20
    v_max3_f32 v73, v73, -v19, -v20
    v_max3_f32 v72, v72, v21, v22
    v_max3_f32 v73, v73, -v21, -v22
    v_max_f32 v72, v72, v23
    v_max_f32_e64 v73, v73, -v23
    s_nop 1
    v_permlane32_swap_b32 v72, v73
    s_nop 0
    v_max_f32 v72, v72, v73
    v_mul_f32 v72, s66, v72
    v_mov_b32 v73, v72
    s_nop 1
    v_permlane32_swap_b32 v72, v73
    s_nop 0
    v_fma_f32 v144, v16, s66, -v72
    v_fma_f32 v152, -v16, s66, -v73
    v_fma_f32 v145, v17, s66, -v72
    v_fma_f32 v153, -v17, s66, -v73
    v_fma_f32 v146, v18, s66, -v72
    v_fma_f32 v154, -v18, s66, -v73
    v_fma_f32 v147, v19, s66, -v72
    v_fma_f32 v155, -v19, s66, -v73
    v_fma_f32 v148, v20, s66, -v72
    v_fma_f32 v156, -v20, s66, -v73
    v_fma_f32 v149, v21, s66, -v72
    v_fma_f32 v157, -v21, s66, -v73
    v_fma_f32 v150, v22, s66, -v72
    v_fma_f32 v158, -v22, s66, -v73
    v_fma_f32 v151, v23, s66, -v72
    v_fma_f32 v159, -v23, s66, -v73
    v_exp_f32 v144, v144
    v_exp_f32 v145, v145
    v_exp_f32 v146, v146
    v_exp_f32 v147, v147
    v_exp_f32 v148, v148
    v_exp_f32 v149, v149
    v_exp_f32 v150, v150
    v_exp_f32 v151, v151
    v_exp_f32 v152, v152
    v_exp_f32 v153, v153
    v_exp_f32 v154, v154
    v_exp_f32 v155, v155
    v_exp_f32 v156, v156
    v_exp_f32 v157, v157
    v_exp_f32 v158, v158
    v_exp_f32 v159, v159
    s_nop 0
    v_add_f32 v72, v144, v145
    v_add_f32 v73, v152, v153
    v_add_f32 v72, v72, v146
    v_add_f32 v73, v73, v154
    v_add_f32 v72, v72, v147
    v_add_f32 v73, v73, v155
    v_add_f32 v72, v72, v148
    v_add_f32 v73, v73, v156
    v_add_f32 v72, v72, v149
    v_add_f32 v73, v73, v157
    v_add_f32 v72, v72, v150
    v_add_f32 v73, v73, v158
    v_add_f32 v72, v72, v151
    v_add_f32 v73, v73, v159
    s_nop 1
    v_permlane32_swap_b32 v72, v73
    s_nop 0
    v_add_f32 v72, v72, v73
    v_rcp_f32 v72, v72
    s_nop 0
    v_mov_b32 v73, v72
    s_nop 1
    v_permlane32_swap_b32 v72, v73
    s_nop 0
    v_mul_f32 v144, v144, v72
    v_mul_f32 v152, v152, v73
    v_mul_f32 v145, v145, v72
    v_mul_f32 v153, v153, v73
    v_mul_f32 v146, v146, v72
    v_mul_f32 v154, v154, v73
    v_mul_f32 v147, v147, v72
    v_mul_f32 v155, v155, v73
    v_mul_f32 v148, v148, v72
    v_mul_f32 v156, v156, v73
    v_mul_f32 v149, v149, v72
    v_mul_f32 v157, v157, v73
    v_mul_f32 v150, v150, v72
    v_mul_f32 v158, v158, v73
    v_mul_f32 v151, v151, v72
    v_mul_f32 v159, v159, v73
    v_cvt_pk_bf16_f32 v80, v144, v145
    v_cvt_pk_bf16_f32 v81, v146, v147
    v_cvt_pk_bf16_f32 v82, v148, v149
    v_cvt_pk_bf16_f32 v83, v150, v151
    v_cvt_pk_bf16_f32 v84, v152, v153
    v_cvt_pk_bf16_f32 v85, v154, v155
    v_cvt_pk_bf16_f32 v86, v156, v157
    v_cvt_pk_bf16_f32 v87, v158, v159
    v_max3_f32 v72, v32, v33, v34
    v_max3_f32 v73, -v32, -v33, -v34
    v_max3_f32 v72, v72, v35, v36
    v_max3_f32 v73, v73, -v35, -v36
    v_max3_f32 v72, v72, v37, v38
    v_max3_f32 v73, v73, -v37, -v38
    v_max_f32 v72, v72, v39
    v_max_f32_e64 v73, v73, -v39
    s_nop 1
    v_permlane32_swap_b32 v72, v73
    s_nop 0
    v_max_f32 v72, v72, v73
    v_mul_f32 v72, s66, v72
    v_mov_b32 v73, v72
    s_nop 1
    v_permlane32_swap_b32 v72, v73
    s_nop 0
    v_fma_f32 v160, v32, s66, -v72
    v_fma_f32 v168, -v32, s66, -v73
    v_fma_f32 v161, v33, s66, -v72
    v_fma_f32 v169, -v33, s66, -v73
    v_fma_f32 v162, v34, s66, -v72
    v_fma_f32 v170, -v34, s66, -v73
    v_fma_f32 v163, v35, s66, -v72
    v_fma_f32 v171, -v35, s66, -v73
    v_fma_f32 v164, v36, s66, -v72
    v_fma_f32 v172, -v36, s66, -v73
    v_fma_f32 v165, v37, s66, -v72
    v_fma_f32 v173, -v37, s66, -v73
    v_fma_f32 v166, v38, s66, -v72
    v_fma_f32 v174, -v38, s66, -v73
    v_fma_f32 v167, v39, s66, -v72
    v_fma_f32 v175, -v39, s66, -v73
    v_exp_f32 v160, v160
    v_exp_f32 v161, v161
    v_exp_f32 v162, v162
    v_exp_f32 v163, v163
    v_exp_f32 v164, v164
    v_exp_f32 v165, v165
    v_exp_f32 v166, v166
    v_exp_f32 v167, v167
    v_exp_f32 v168, v168
    v_exp_f32 v169, v169
    v_exp_f32 v170, v170
    v_exp_f32 v171, v171
    v_exp_f32 v172, v172
    v_exp_f32 v173, v173
    v_exp_f32 v174, v174
    v_exp_f32 v175, v175
    s_nop 0
    v_add_f32 v72, v160, v161
    v_add_f32 v73, v168, v169
    v_add_f32 v72, v72, v162
    v_add_f32 v73, v73, v170
    v_add_f32 v72, v72, v163
    v_add_f32 v73, v73, v171
    v_add_f32 v72, v72, v164
    v_add_f32 v73, v73, v172
    v_add_f32 v72, v72, v165
    v_add_f32 v73, v73, v173
    v_add_f32 v72, v72, v166
    v_add_f32 v73, v73, v174
    v_add_f32 v72, v72, v167
    v_add_f32 v73, v73, v175
    s_nop 1
    v_permlane32_swap_b32 v72, v73
    s_nop 0
    v_add_f32 v72, v72, v73
    v_rcp_f32 v72, v72
    s_nop 0
    v_mov_b32 v73, v72
    s_nop 1
    v_permlane32_swap_b32 v72, v73
    s_nop 0
    v_mul_f32 v160, v160, v72
    v_mul_f32 v168, v168, v73
    v_mul_f32 v161, v161, v72
    v_mul_f32 v169, v169, v73
    v_mul_f32 v162, v162, v72
    v_mul_f32 v170, v170, v73
    v_mul_f32 v163, v163, v72
    v_mul_f32 v171, v171, v73
    v_mul_f32 v164, v164, v72
    v_mul_f32 v172, v172, v73
    v_mul_f32 v165, v165, v72
    v_mul_f32 v173, v173, v73
    v_mul_f32 v166, v166, v72
    v_mul_f32 v174, v174, v73
    v_mul_f32 v167, v167, v72
    v_mul_f32 v175, v175, v73
    v_cvt_pk_bf16_f32 v88, v160, v161
    v_cvt_pk_bf16_f32 v89, v162, v163
    v_cvt_pk_bf16_f32 v90, v164, v165
    v_cvt_pk_bf16_f32 v91, v166, v167
    v_cvt_pk_bf16_f32 v92, v168, v169
    v_cvt_pk_bf16_f32 v93, v170, v171
    v_cvt_pk_bf16_f32 v94, v172, v173
    v_cvt_pk_bf16_f32 v95, v174, v175
    v_mfma_f32_32x32x16_bf16 v[96:111], v[80:83], v[128:131], 0
    v_mfma_f32_32x32x16_bf16 v[96:111], v[84:87], v[132:135], v[96:111]
    s_nop 7
    s_branch fz_kernel_smr0
fz_kernel_l2s:
    s_mov_b32 s97, 0x8000
fz_kernel_l2l:
    buffer_load_dword v240, v243, s[44:47], s92 offen sc1
    s_sub_u32 s97, s97, 1
    s_cbranch_scc1 fz_kernel_l2k
    s_waitcnt vmcnt(0) lgkmcnt(0)
    v_cmp_ne_u32 vcc, v249, v240
    s_cbranch_vccnz fz_kernel_l2l
    s_branch fz_kernel_l2k
fz_kernel_cn0s:
    s_mov_b32 s97, 0x8000
fz_kernel_cn0l:
    ds_read_b32 v79, v242 offset:0
    s_sub_u32 s97, s97, 1
    s_cbranch_scc1 fz_kernel_cn0k
    s_waitcnt vmcnt(0) lgkmcnt(0)
    v_cmp_ne_u32 vcc, 0xeeeeeee8, v79
    s_cbranch_vccnz fz_kernel_cn0l
    s_branch fz_kernel_cn0k
fz_kernel_wfs:
    s_mov_b32 s97, 0x8000
fz_kernel_wfl:
    buffer_load_dword v240, v243, s[44:47], s92 offen sc1
    s_sub_u32 s97, s97, 1
    s_cbranch_scc1 fz_kernel_wfk
    s_waitcnt vmcnt(0) lgkmcnt(0)
    v_cmp_ne_u32 vcc, v249, v240
    s_cbranch_vccnz fz_kernel_wfl
    s_branch fz_kernel_wfk
fz_kernel_kss:
    s_mov_b32 s97, 0x8000
fz_kernel_ksl:
    buffer_load_dwordx4 v[96:99], v241, s[44:47], s96 offen offset:0 sc1
    buffer_load_dwordx4 v[100:103], v241, s[44:47], s96 offen offset:1024 sc1
    buffer_load_dwordx4 v[104:107], v241, s[44:47], s96 offen offset:2048 sc1
    buffer_load_dwordx4 v[108:111], v241, s[44:47], s96 offen offset:3072 sc1
    buffer_load_dwordx4 v[112:115], v241, s[44:47], s93 offen offset:0 sc1
    buffer_load_dwordx4 v[116:119], v241, s[44:47], s93 offen offset:1024 sc1
    buffer_load_dwordx4 v[120:123], v241, s[44:47], s93 offen offset:2048 sc1
    buffer_load_dwordx4 v[124:127], v241, s[44:47], s93 offen offset:3072 sc1
    buffer_load_dwordx2 v[76:77], v247, s[44:47], s92 offen sc1
    s_sub_u32 s97, s97, 1
    s_cbranch_scc1 fz_kernel_ksk
    s_waitcnt vmcnt(0) lgkmcnt(0)
    v_max3_u32 v72, v77, v96, v102
    v_max3_u32 v72, v72, v104, v110
    v_max3_u32 v72, v72, v112, v118
    v_max3_u32 v72, v72, v120, v126
    v_min3_u32 v73, v77, v96, v102
    v_min3_u32 v73, v73, v104, v110
    v_min3_u32 v73, v73, v112, v118
    v_min3_u32 v73, v73, v120, v126
    v_cmp_ne_u32 vcc, v249, v72
    v_cmp_ne_u32_e64 s[90:91], v249, v73
    s_or_b64 vcc, vcc, s[90:91]
    s_cbranch_vccnz fz_kernel_ksl
    s_branch fz_kernel_ksk
fz_kernel_gs:
    s_mov_b32 s97, 0x8000
fz_kernel_gl:
    buffer_load_dwordx2 v[76:77], v247, s[44:47], s96 offen sc1
    s_sub_u32 s97, s97, 1
    s_cbranch_scc1 fz_kernel_gk
    s_waitcnt vmcnt(0) lgkmcnt(0)
    v_cmp_ne_u32 vcc, v249, v77
    s_cbranch_vccnz fz_kernel_gl
    s_branch fz_kernel_gk
fz_kernel_cn1s:
    s_mov_b32 s97, 0x8000
fz_kernel_cn1l:
    ds_read_b32 v79, v242 offset:64
    s_sub_u32 s97, s97, 1
    s_cbranch_scc1 fz_kernel_cn1k
    s_waitcnt vmcnt(0) lgkmcnt(0)
    v_cmp_ne_u32 vcc, 0xeeeeeee8, v79
    s_cbranch_vccnz fz_kernel_cn1l
    s_branch fz_kernel_cn1k
fz_kernel_f2s:
    s_mov_b32 s97, 0x8000
fz_kernel_f2l:
    buffer_load_dword v240, v243, s[44:47], 0 offen sc1
    s_sub_u32 s97, s97, 1
    s_cbranch_scc1 fz_kernel_f2k
    s_waitcnt vmcnt(0) lgkmcnt(0)
    v_xor_b32 v72, v249, v240
    v_cmp_lt_u32 vcc, 1, v72
    s_cbranch_vccnz fz_kernel_f2l
    s_branch fz_kernel_f2k
fz_kernel_y0:
    buffer_load_dwordx4 v[0:3], v251, s[44:47], s72 offen offset:0 sc1
    s_bitset1_b32 s94, 0
    s_branch fz_kernel_n0
fz_kernel_y1:
    buffer_load_dwordx4 v[4:7], v251, s[44:47], s72 offen offset:1024 sc1
    s_bitset1_b32 s94, 1
    s_branch fz_kernel_n1
fz_kernel_y2:
    buffer_load_dwordx4 v[8:11], v251, s[44:47], s72 offen offset:2048 sc1
    s_bitset1_b32 s94, 2
    s_branch fz_kernel_n2
fz_kernel_y3:
    buffer_load_dwordx4 v[12:15], v251, s[44:47], s72 offen offset:3072 sc1
    s_bitset1_b32 s94, 3
    s_branch fz_kernel_n3
fz_kernel_y4:
    buffer_load_dwordx4 v[48:51], v251, s[44:47], s93 offen offset:0 sc1
    s_bitset1_b32 s94, 4
    s_branch fz_kernel_n4
fz_kernel_y5:
    buffer_load_dwordx4 v[52:55], v251, s[44:47], s93 offen offset:1024 sc1
    s_bitset1_b32 s94, 5
    s_branch fz_kernel_n5
fz_kernel_y6:
    buffer_load_dwordx4 v[56:59], v251, s[44:47], s93 offen offset:2048 sc1
    s_bitset1_b32 s94, 6
    s_branch fz_kernel_n6
fz_kernel_y7:
    buffer_load_dwordx4 v[60:63], v251, s[44:47], s93 offen offset:3072 sc1
    s_bitset1_b32 s94, 7
    s_branch fz_kernel_n7
fz_kernel_slow:
    v_mov_b32 v72, 0xff800000
    v_mov_b32 v75, v65
    s_mov_b32 s66, 0
fz_kernel_mloop:
    ds_read_b128 v[52:55], v75
    v_add_u32 v75, 2064, v75
    s_add_u32 s66, s66, 1
    s_waitcnt lgkmcnt(0)
    v_mfma_f32_32x32x16_bf16 v[32:47], v[52:55], v[48:51], 0
    s_cmp_lt_u32 s66, 64
    s_nop 11
    v_max3_f32 v72, v72, v32, v33
    v_max3_f32 v72, v72, v34, v35
    v_max3_f32 v72, v72, v36, v37
    v_max3_f32 v72, v72, v38, v39
    v_max3_f32 v72, v72, v40, v41
    v_max3_f32 v72, v72, v42, v43
    v_max3_f32 v72, v72, v44, v45
    v_max3_f32 v72, v72, v46, v47
    s_cbranch_scc1 fz_kernel_mloop
    v_mov_b32 v73, v72
    s_nop 1
    v_permlane32_swap_b32 v72, v73
    s_nop 0
    v_max_f32 v72, v72, v73
    v_xor_b32 v16, 0x80000000, v72
    v_mov_b32 v0, 0
    v_xor_b32 v17, 0x80000000, v72
    v_mov_b32 v1, 0
    v_xor_b32 v18, 0x80000000, v72
    v_mov_b32 v2, 0
    v_xor_b32 v19, 0x80000000, v72
    v_mov_b32 v3, 0
    v_xor_b32 v20, 0x80000000, v72
    v_mov_b32 v4, 0
    v_xor_b32 v21, 0x80000000, v72
    v_mov_b32 v5, 0
    v_xor_b32 v22, 0x80000000, v72
    v_mov_b32 v6, 0
    v_xor_b32 v23, 0x80000000, v72
    v_mov_b32 v7, 0
    v_xor_b32 v24, 0x80000000, v72
    v_mov_b32 v8, 0
    v_xor_b32 v25, 0x80000000, v72
    v_mov_b32 v9, 0
    v_xor_b32 v26, 0x80000000, v72
    v_mov_b32 v10, 0
    v_xor_b32 v27, 0x80000000, v72
    v_mov_b32 v11, 0
    v_xor_b32 v28, 0x80000000, v72
    v_mov_b32 v12, 0
    v_xor_b32 v29, 0x80000000, v72
    v_mov_b32 v13, 0
    v_xor_b32 v30, 0x80000000, v72
    v_mov_b32 v14, 0
    v_xor_b32 v31, 0x80000000, v72
    v_mov_b32 v15, 0
    v_mov_b32 v75, v65
    v_mov_b32 v76, v67
    s_mov_b32 s66, 0
fz_kernel_sloop:
    ds_read_b128 v[52:55], v75
    s_mov_b64 exec, s[26:27]
    ds_read_b128 v[56:59], v76
    ds_read_b128 v[60:63], v76 offset:512
    s_mov_b64 exec, -1
    v_add_u32 v75, 2064, v75
    v_add_u32 v76, 2064, v76
    s_add_u32 s66, s66, 1
    s_waitcnt lgkmcnt(0)
    v_mfma_f32_32x32x16_bf16 v[32:47], v[52:55], v[48:51], v[16:31]
    s_cmp_lt_u32 s66, 64
    s_nop 11
    v_exp_f32 v32, v32
    v_exp_f32 v33, v33
    v_exp_f32 v34, v34
    v_exp_f32 v35, v35
    v_exp_f32 v36, v36
    v_exp_f32 v37, v37
    v_exp_f32 v38, v38
    v_exp_f32 v39, v39
    v_exp_f32 v40, v40
    v_exp_f32 v41, v41
    v_exp_f32 v42, v42
    v_exp_f32 v43, v43
    v_exp_f32 v44, v44
    v_exp_f32 v45, v45
    v_exp_f32 v46, v46
    v_exp_f32 v47, v47
    s_nop 1
    v_smfmac_f32_32x32x32_bf16 v[0:15], v[56:59], v[32:39], v64
    v_smfmac_f32_32x32x32_bf16 v[0:15], v[60:63], v[40:47], v64
    s_nop 7
    s_cbranch_scc1 fz_kernel_sloop
    s_nop 7
    v_rcp_f32 v74, v8
    s_nop 0
    s_branch fz_kernel_fin
fz_kernel_end:
.section .rodata,"a"
.p2align 6
.amdhsa_kernel fz_kernel
  .amdhsa_next_free_vgpr 256
  .amdhsa_next_free_sgpr 102
  .amdhsa_accum_offset 256
  .amdhsa_group_segment_fixed_size 0
  .amdhsa_kernarg_size 88
  .amdhsa_user_sgpr_count 2
  .amdhsa_user_sgpr_kernarg_segment_ptr 1
  .amdhsa_system_sgpr_workgroup_id_x 1
.end_amdhsa_kernel
```
